```python
import torch

def _softmax(x, axis=-1):
    return torch.softmax(x, dim=axis)
def _gelu(x):
    return torch.nn.functional.gelu(x, approximate="tanh")
def _silu(x):
    return torch.nn.functional.silu(x)
def _sigmoid(x):
    return torch.sigmoid(x)
def _layernorm(x, axis=-1, eps=1e-5):
    m = x.mean(dim=axis, keepdim=True)
    v = x.var(dim=axis, keepdim=True, unbiased=False)
    return (x - m) / torch.sqrt(v + eps)
def _scatter_add(tgt, idx, src, axis=0):
    return tgt.clone().index_add_(axis, idx, src)
def _segment_sum(src, seg, n):
    out = torch.zeros((n,) + src.shape[1:], dtype=src.dtype)
    return out.index_add_(0, seg, src)
def _pad(x, pw):
    flat = tuple(v for pair in reversed(pw) for v in pair)
    return torch.nn.functional.pad(x, flat)

kernel_name = 'sequential_preLN__ssm_conv_h3__mixer_s_mlp__prompt'

def setup_inputs():

    _w = (lambda a: (lambda t: t.to(torch.bfloat16) if t.is_floating_point() else t)(torch.as_tensor(a)))
    def _A_setup():
        B, S, D = 1, 2048, 512
        ks = 4
        return {
            "q": _w((lambda *s: torch.randn(*s, dtype=torch.bfloat16) * 0.05)(B, S, D)),
            "k": _w((lambda *s: torch.randn(*s, dtype=torch.bfloat16) * 0.4)(B, S, D)),
            "v": _w((lambda *s: torch.randn(*s, dtype=torch.bfloat16) * 0.4)(B, S, D)),
            "shift_k": _w((lambda *s: torch.randn(*s, dtype=torch.bfloat16) * 0.4)(D, ks) * 0.5),
            "ssm_k": _w((lambda *s: torch.randn(*s, dtype=torch.bfloat16) * 0.4)(D, S) * (1.0 / S ** 0.5)),
            "ssm_D": _w((lambda *s: torch.randn(*s, dtype=torch.bfloat16) * 0.4)(D)),
        }
    _A_in = _A_setup()

    def _B_setup():
        B, S, D, F = 1, 2048, 512, 1376
        return {
            "x":  _w((lambda *s: torch.randn(*s, dtype=torch.bfloat16) * 0.05)(B, S, D)),
            "w1": _w((lambda *s: torch.randn(*s, dtype=torch.bfloat16) * 3.2)(D, D) * (D ** -0.5)),
            "w2": _w((lambda *s: torch.randn(*s, dtype=torch.bfloat16) * 3.2)(D, D) * (D ** -0.5)),
            "w3": _w((lambda *s: torch.randn(*s, dtype=torch.bfloat16) * 3.2)(D, F) * (D ** -0.5)),
            "w4": _w((lambda *s: torch.randn(*s, dtype=torch.bfloat16) * 1.6)(F, D) * (F ** -0.5)),
        }
    _B_in = _B_setup()

    return {
        "A_q": _A_in["q"],
        "A_k": _A_in["k"],
        "A_v": _A_in["v"],
        "A_shift_k": _A_in["shift_k"],
        "A_ssm_k": _A_in["ssm_k"],
        "A_ssm_D": _A_in["ssm_D"],
        "B_x": _B_in["x"],
        "B_w1": _B_in["w1"],
        "B_w2": _B_in["w2"],
        "B_w3": _B_in["w3"],
        "B_w4": _B_in["w4"],
    }

def reference(A_q, A_k, A_v, A_shift_k, A_ssm_k, A_ssm_D, B_x, B_w1, B_w2, B_w3, B_w4):
    def _A_ref(q, k, v, shift_k, ssm_k, ssm_D):
        B, S, D = q.shape
        ks = shift_k.shape[-1]
        k_pad = _pad(k, ((0, 0), (ks - 1, 0), (0, 0)))
        k_shift = torch.zeros_like(k)
        for t in range(ks):
            k_shift = k_shift + k_pad[:, t:t + S, :] * shift_k[:, ks - 1 - t][None, None, :]
        kv = k_shift * v
        L = 2 * S
        kv_pad = _pad(kv, ((0, 0), (0, S), (0, 0)))
        kf_pad = _pad(ssm_k, ((0, 0), (0, S)))
        kv_f = (lambda x, axes=(-2,-1): torch.fft.rfft2(x.float(), dim=axes))(kv_pad[:, None, :, :], axes=(1, 2))
        kf_f = (lambda x, axes=(-2,-1): torch.fft.rfft2(x.float(), dim=axes))(kf_pad[:, None, :], axes=(1, 2))
        kf_f = (lambda x, *d: x.permute(*d))(kf_f, 1, 2, 0)
        y_f = kv_f * kf_f[None, :, :, :]
        y = (lambda x, s, axes=(-2,-1): torch.fft.irfft2(x, s=s, dim=axes).to(torch.bfloat16))(y_f, (1, L), axes=(1, 2))[:, 0, :S, :]
        y = y + kv * ssm_D[None, None, :]
        return q * y

    def _B_ref(x, w1, w2, w3, w4):
        B, S, D = x.shape
        h = _gelu(_layernorm(x, axis=-1) @ w1)
        c = D // 4
        g0 = _pad(h[:, :, 0*c:1*c], ((0, 0), (1, 0), (0, 0)))[:, :S, :]
        g1 = _pad(h[:, :, 1*c:2*c], ((0, 0), (0, 1), (0, 0)))[:, 1:, :]
        g2 = _pad(h[:, :, 2*c:3*c], ((0, 0), (2, 0), (0, 0)))[:, :S, :]
        g3 = _pad(h[:, :, 3*c:   ], ((0, 0), (0, 2), (0, 0)))[:, 2:, :]
        hs = torch.concatenate([g0, g1, g2, g3], axis=-1) @ w2
        x1 = x + hs
        h2 = _gelu(_layernorm(x1, axis=-1) @ w3) @ w4
        return x1 + h2

    x = A_q
    h = x + _A_ref(_layernorm(x, axis=-1), A_k, A_v, A_shift_k, A_ssm_k, A_ssm_D)
    h2 = h + _B_ref(_layernorm(h, axis=-1), B_w1, B_w2, B_w3, B_w4)
    return h2
```

```asm
; @launch grid=(256,1,1) block=(256,1,1) lds=163840
.amdgcn_target "amdgcn-amd-amdhsa--gfx950"
.text
.globl sequential_preLN__ssm_conv_h3__mixer_s_mlp__prompt_kernel
.p2align 8
.type sequential_preLN__ssm_conv_h3__mixer_s_mlp__prompt_kernel,@function
sequential_preLN__ssm_conv_h3__mixer_s_mlp__prompt_kernel:
    s_cmp_ge_u32 s2, 256
    s_cbranch_scc1 KS_END
    s_load_dwordx8 s[48:55], s[0:1], 0
    s_load_dwordx4 s[56:59], s[0:1], 32
    s_load_dwordx2 s[68:69], s[0:1], 104
    s_load_dwordx2 s[70:71], s[0:1], 88
    s_load_dwordx8 s[36:43], s[0:1], 56
    s_getpc_b64 s[32:33]
KS_PC:
    s_mov_b32 s34, KS_END-KS_PC
    s_mov_b32 s35, 0x20000
    v_lshlrev_b32 v8, 7, v0
    s_cmp_lt_u32 s2, 8
    s_cselect_b32 s34, s34, 0
    buffer_load_dword v21, v8, s[32:35], 0 offen
    v_lshrrev_b32 v2, 6, v0
    v_and_b32 v1, 63, v0
    v_readfirstlane_b32 s5, v2
    s_and_b32 s76, s2, 7
    s_lshr_b32 s77, s2, 3
    v_and_b32 v4, 7, v1
    v_lshl_add_u32 v4, v2, 3, v4
    v_lshrrev_b32 v5, 3, v1
    s_lshl_b32 s60, s77, 6
    v_lshl_add_u32 v105, v5, 3, s60
    s_xor_b32 s60, s76, 0
    s_lshl_b32 s60, s60, 7
    v_lshl_add_u32 v106, v4, 2, s60
    v_lshl_add_u32 v5, v105, 10, v106
    v_subrev_u32 v6, 0xc00, v5
    v_cmp_eq_u32 vcc, 0, v105
    v_mov_b32 v7, 0x80000000
    s_nop 0
    v_cndmask_b32 v6, v6, v7, vcc
    v_lshlrev_b32 v7, 2, v106
    s_movk_i32 s61, 0x1000
    s_lshr_b32 s6, s5, 1
    s_and_b32 s7, s5, 1
    s_lshr_b32 s3, s77, 3
    s_lshl2_add_u32 s3, s76, s3
    s_and_b32 s4, s77, 7
    v_lshlrev_b32 v2, 4, v1
    s_xor_b32 s79, s76, 0
    s_lshl_b32 s79, s79, 5
    s_add_u32 s79, s79, s77
    s_lshl_b32 s62, s79, 2
    s_mov_b32 s63, 0xe99800
    s_waitcnt lgkmcnt(0)
    s_mov_b32 s12, s50
    s_mov_b32 s13, s51
    s_mov_b32 s14, 0x200000
    s_mov_b32 s15, 0x20000
    s_load_dword s67, s[68:69], s63
    s_load_dword s78, s[58:59], s62
    buffer_load_dword v10, v6, s[12:15], 0 offen offset:0
    buffer_load_dword v11, v6, s[12:15], 0 offen offset:1024
    buffer_load_dword v12, v6, s[12:15], 0 offen offset:2048
    buffer_load_dword v13, v5, s[12:15], 0 offen offset:0
    buffer_load_dword v14, v5, s[12:15], 0 offen offset:1024
    buffer_load_dword v15, v5, s[12:15], 0 offen offset:2048
    buffer_load_dword v16, v5, s[12:15], 0 offen offset:3072
    buffer_load_dword v17, v5, s[12:15], s61 offen offset:0
    buffer_load_dword v18, v5, s[12:15], s61 offen offset:1024
    buffer_load_dword v19, v5, s[12:15], s61 offen offset:2048
    buffer_load_dword v20, v5, s[12:15], s61 offen offset:3072
    s_mov_b64 s[16:17], s[36:37]
    s_mov_b64 s[28:29], s[40:41]
    s_cmp_eq_u32 s7, 0
    s_cselect_b64 s[36:37], s[36:37], s[38:39]
    s_cselect_b64 s[40:41], s[40:41], s[42:43]
    s_cmp_eq_u32 s6, 0
    s_cselect_b64 s[72:73], s[36:37], s[40:41]
    s_mov_b32 s40, s54
    s_mov_b32 s41, s55
    s_mov_b32 s42, 0x1000
    s_mov_b32 s43, 0x20000
    buffer_load_dwordx4 v[30:33], v7, s[40:43], 0 offen
    s_mov_b32 s20, s52
    s_mov_b32 s21, s53
    s_mov_b32 s22, 0x200000
    s_mov_b32 s23, 0x20000
    buffer_load_dword v22, v5, s[20:23], 0 offen offset:0
    buffer_load_dword v23, v5, s[20:23], 0 offen offset:1024
    buffer_load_dword v24, v5, s[20:23], 0 offen offset:2048
    buffer_load_dword v25, v5, s[20:23], 0 offen offset:3072
    buffer_load_dword v26, v5, s[20:23], s61 offen offset:0
    buffer_load_dword v27, v5, s[20:23], s61 offen offset:1024
    buffer_load_dword v28, v5, s[20:23], s61 offen offset:2048
    buffer_load_dword v29, v5, s[20:23], s61 offen offset:3072
    s_add_u32 s36, s68, 0xe40000
    s_addc_u32 s37, s69, 0
    s_mov_b32 s38, 0xe0000
    s_mov_b32 s39, 0x20000
    s_lshl1_add_u32 s60, s4, s6
    s_lshl4_add_u32 s62, s3, s60
    s_lshl_b32 s62, s62, 12
    s_add_u32 s56, s56, s62
    s_addc_u32 s57, s57, 0
    s_mov_b64 s[46:47], s[56:57]
    s_lshl_b32 s62, s7, 2
    v_add_u32 v116, s62, v2
    s_mul_i32 s63, s6, 8448
    s_mul_i32 s64, s7, 4224
    s_add_u32 s66, s64, s63
    v_mov_b32 v117, 0x80000000
    v_cmp_eq_u32 vcc, 7, v1
    s_cmp_eq_u32 s7, 1
    s_cselect_b64 s[52:53], vcc, 0
    v_cndmask_b32 v117, v117, 0, s[52:53]
    v_min_u32 v107, 7, v1
    v_lshlrev_b32 v107, 2, v107
    v_add_u32 v107, s66, v107
    s_mov_b32 s32, s46
    s_mov_b32 s33, s47
    s_mov_b32 s34, 0x1000
    s_mov_b32 s35, 0x20000
    s_add_u32 m0, s66, 32
    s_nop 0
    buffer_load_dwordx4 v116, s[32:35], 0 offen offset:0 lds
    buffer_load_dwordx4 v116, s[32:35], 0 offen offset:1024 lds
    buffer_load_dwordx4 v116, s[32:35], 0 offen offset:2048 lds
    buffer_load_dwordx4 v116, s[32:35], 0 offen offset:3072 lds
    buffer_load_dword v108, v117, s[32:35], 0 offen
    s_cmp_lt_u32 s5, 2
    s_cselect_b32 s62, 16, 43
    s_lshl_b32 s62, s62, 7
    s_mul_i32 s52, s2, s62
    s_add_u32 s62, s52, s62
    s_mov_b32 s45, s52
    s_mov_b32 s44, s62
    v_lshlrev_b32 v109, 7, v1
    s_mov_b32 s8, s68
    s_mov_b32 s9, s69
    s_mov_b32 s10, 0xf20000
    s_mov_b32 s11, 0x20000
    v_lshlrev_b32 v8, 21, v1
    s_lshl_b32 s62, s2, 7
    v_add_u32 v8, s62, v8
    v_subrev_u32 v9, 8, v1
    v_lshlrev_b32 v9, 7, v9
    s_mul_i32 s62, s2, 640
    s_add_u32 s62, s62, 0x600000
    v_add_u32 v9, s62, v9
    v_cmp_gt_u32 vcc, 8, v1
    s_nop 1
    v_cndmask_b32 v8, v9, v8, vcc
    s_and_b32 s62, s2, 63
    s_lshl_b32 s62, s62, 7
    s_add_u32 s62, s62, 0xe98000
    v_mov_b32 v9, s62
    v_cmp_gt_u32 vcc, 13, v1
    s_nop 1
    v_cndmask_b32 v8, v9, v8, vcc
    v_mov_b32 v9, 0x40000000
    v_cmp_gt_u32 vcc, 14, v1
    s_nop 1
    v_cndmask_b32 v8, v9, v8, vcc
    s_cmp_eq_u32 s5, 0
    s_cselect_b32 s10, s10, 0
    buffer_load_dword v115, v8, s[8:11], 0 offen
    s_lshl_b32 s79, s79, 4
    s_mov_b32 s8, s48
    s_mov_b32 s9, s49
    s_mov_b32 s10, 0x200000
    s_mov_b32 s11, 0x20000
    s_mov_b32 s12, s68
    s_mov_b32 s13, s69
    s_mov_b32 s14, 0x621000
    s_mov_b32 s15, 0x20000
    s_mul_i32 s62, s3, 176128
    s_add_u32 s62, s62, 0x10000
    s_add_u32 s20, s68, s62
    s_addc_u32 s21, s69, 0
    s_mov_b32 s22, 0x11000
    s_mov_b32 s23, 0x20000
    s_lshl_b32 s62, s3, 16
    s_add_u32 s40, s70, s62
    s_addc_u32 s41, s71, 0
    s_mov_b32 s42, 0x10000
    s_mov_b32 s43, 0x20000
    s_add_u32 s24, s68, 0x10800
    s_addc_u32 s25, s69, 0
    s_mov_b32 s26, 0x560000
    s_mov_b32 s27, 0x20000
    s_mul_i32 s62, s3, 176128
    s_add_u32 s62, s62, 0x10800
    s_lshl_b32 s60, s60, 12
    s_add_u32 s60, s60, s62
    s_add_u32 s32, s68, s60
    s_addc_u32 s33, s69, 0
    s_mov_b32 s34, 0x1000
    s_mov_b32 s35, 0x20000
    s_mov_b32 s18, 0x80000
    s_mov_b32 s19, 0x20000
    s_mov_b32 s30, 1409024
    s_mov_b32 s31, 0x20000
    s_getreg_b32 s74, hwreg(HW_REG_XCC_ID, 0, 4)
    s_mul_i32 s65, s5, 24576
    s_add_u32 s65, s65, 65536
    s_lshl1_add_u32 s75, s4, s7
    s_lshl_b32 s75, s75, 6
    s_lshl_b32 s63, s6, 18
    s_add_u32 s63, s63, s75
    v_lshrrev_b32 v8, 2, v1
    v_and_b32 v9, 3, v1
    v_lshlrev_b32 v8, 10, v8
    v_lshl_add_u32 v252, v9, 4, v8
    v_lshrrev_b32 v8, 5, v1
    v_bfe_u32 v4, v1, 2, 2
    v_lshl_add_u32 v8, v8, 3, v4
    v_lshlrev_b32 v8, 6, v8
    v_and_b32 v4, 1, v9
    v_lshl_add_u32 v8, v4, 5, v8
    v_lshrrev_b32 v4, 1, v9
    v_lshl_add_u32 v8, v4, 3, v8
    v_bfe_u32 v4, v1, 4, 1
    v_lshl_add_u32 v8, v4, 4, v8
    v_add_u32 v253, s65, v8
    v_min_u32 v3, 31, v1
    v_lshlrev_b32 v9, 3, v3
    v_lshlrev_b32 v3, 2, v3
    v_lshrrev_b32 v104, 5, v106
    v_mul_u32_u24 v104, 176128, v104
    v_and_b32 v8, 31, v106
    v_lshl_add_u32 v104, v8, 11, v104
    v_sub_u32 v8, 2040, v105
    v_lshl_add_u32 v104, v8, 1, v104
    s_lshl_b32 s58, s3, 6
    s_lshl3_add_u32 s58, s4, s58
    s_lshl_b32 s58, s58, 10
    v_lshlrev_b32 v6, 7, v0
    v_add_u32 v7, s58, v6
    v_mov_b32 v4, 0x40000000
    v_cmp_gt_u32 vcc, 64, v0
    s_nop 1
    v_cndmask_b32 v110, v4, v7, vcc
    s_lshl_b32 s53, s76, 7
    s_mul_i32 s58, s4, 14
    v_add_u32 v6, s58, v0
    v_subrev_u32 v6, 64, v6
    v_lshlrev_b32 v7, 7, v6
    s_mul_i32 s58, s3, 176128
    s_add_u32 s58, s58, 0x10000
    v_add_u32 v111, s58, v7
    s_add_u32 s59, s58, 0x10000
    v_add_u32 v8, s59, v7
    v_cmp_gt_u32 vcc, 16, v6
    s_nop 1
    v_cndmask_b32 v111, v8, v111, vcc
    s_lshl_b32 s59, s3, 13
    s_add_u32 s59, s59, 0xe4f000
    v_add_u32 v8, s59, v7
    v_cmp_gt_u32 vcc, 32, v6
    s_nop 1
    v_cndmask_b32 v111, v8, v111, vcc
    s_lshl_b32 s59, s3, 10
    s_add_u32 s59, s59, 0xe3d000
    v_add_u32 v8, s59, v7
    v_cmp_gt_u32 vcc, 96, v6
    s_nop 1
    v_cndmask_b32 v111, v8, v111, vcc
    s_lshl_b32 s59, s3, 10
    s_add_u32 s59, s59, 0xe8cc00
    v_add_u32 v8, s59, v7
    v_cmp_gt_u32 vcc, 104, v6
    s_nop 1
    v_cndmask_b32 v111, v8, v111, vcc
    v_cmp_gt_u32 vcc, 109, v6
    s_nop 1
    v_cndmask_b32 v111, v4, v111, vcc
    v_subrev_u32 v8, 64, v0
    v_cmp_gt_u32 vcc, 14, v8
    s_nop 1
    v_cndmask_b32 v111, v4, v111, vcc
    s_lshl_b32 s57, s76, 8
    s_add_u32 s57, s57, 0x59000
    s_mov_b32 s55, s57
    s_mov_b32 s48, s68
    s_mov_b32 s49, s69
    s_mov_b32 s50, 0xf20000
    s_mov_b32 s51, 0x20000
    buffer_load_dword v114, v111, s[48:51], 0 offen
    s_waitcnt vmcnt(26)
    v_lshlrev_b32 v34, 16, v10
    v_and_b32 v35, 0xffff0000, v10
    s_waitcnt vmcnt(25)
    v_lshlrev_b32 v36, 16, v11
    v_and_b32 v37, 0xffff0000, v11
    s_waitcnt vmcnt(24)
    v_lshlrev_b32 v38, 16, v12
    v_and_b32 v39, 0xffff0000, v12
    s_waitcnt vmcnt(23)
    v_lshlrev_b32 v40, 16, v13
    v_and_b32 v41, 0xffff0000, v13
    s_waitcnt vmcnt(22)
    v_lshlrev_b32 v42, 16, v14
    v_and_b32 v43, 0xffff0000, v14
    s_waitcnt vmcnt(21)
    v_lshlrev_b32 v44, 16, v15
    v_and_b32 v45, 0xffff0000, v15
    s_waitcnt vmcnt(20)
    v_lshlrev_b32 v46, 16, v16
    v_and_b32 v47, 0xffff0000, v16
    s_waitcnt vmcnt(19)
    v_lshlrev_b32 v48, 16, v17
    v_and_b32 v49, 0xffff0000, v17
    s_waitcnt vmcnt(18)
    v_lshlrev_b32 v50, 16, v18
    v_and_b32 v51, 0xffff0000, v18
    s_waitcnt vmcnt(17)
    v_lshlrev_b32 v52, 16, v19
    v_and_b32 v53, 0xffff0000, v19
    s_waitcnt vmcnt(16)
    v_lshlrev_b32 v54, 16, v20
    v_and_b32 v55, 0xffff0000, v20
    s_waitcnt vmcnt(15)
    v_lshlrev_b32 v72, 16, v30
    v_lshlrev_b32 v73, 16, v32
    v_and_b32 v74, 0xffff0000, v30
    v_and_b32 v75, 0xffff0000, v32
    v_lshlrev_b32 v76, 16, v31
    v_lshlrev_b32 v77, 16, v33
    s_nop 0
    v_and_b32 v78, 0xffff0000, v31
    v_and_b32 v79, 0xffff0000, v33
    v_pk_mul_f32 v[80:81], v[34:35], v[78:79]
    v_pk_mul_f32 v[82:83], v[36:37], v[78:79]
    v_pk_mul_f32 v[84:85], v[38:39], v[78:79]
    v_pk_mul_f32 v[86:87], v[40:41], v[78:79]
    v_pk_mul_f32 v[88:89], v[42:43], v[78:79]
    v_pk_mul_f32 v[90:91], v[44:45], v[78:79]
    v_pk_mul_f32 v[92:93], v[46:47], v[78:79]
    v_pk_mul_f32 v[94:95], v[48:49], v[78:79]
    v_pk_fma_f32 v[80:81], v[36:37], v[76:77], v[80:81]
    v_pk_fma_f32 v[82:83], v[38:39], v[76:77], v[82:83]
    v_pk_fma_f32 v[84:85], v[40:41], v[76:77], v[84:85]
    v_pk_fma_f32 v[86:87], v[42:43], v[76:77], v[86:87]
    v_pk_fma_f32 v[88:89], v[44:45], v[76:77], v[88:89]
    v_pk_fma_f32 v[90:91], v[46:47], v[76:77], v[90:91]
    v_pk_fma_f32 v[92:93], v[48:49], v[76:77], v[92:93]
    v_pk_fma_f32 v[94:95], v[50:51], v[76:77], v[94:95]
    v_pk_fma_f32 v[80:81], v[38:39], v[74:75], v[80:81]
    v_pk_fma_f32 v[82:83], v[40:41], v[74:75], v[82:83]
    v_pk_fma_f32 v[84:85], v[42:43], v[74:75], v[84:85]
    v_pk_fma_f32 v[86:87], v[44:45], v[74:75], v[86:87]
    v_pk_fma_f32 v[88:89], v[46:47], v[74:75], v[88:89]
    v_pk_fma_f32 v[90:91], v[48:49], v[74:75], v[90:91]
    v_pk_fma_f32 v[92:93], v[50:51], v[74:75], v[92:93]
    v_pk_fma_f32 v[94:95], v[52:53], v[74:75], v[94:95]
    v_pk_fma_f32 v[80:81], v[40:41], v[72:73], v[80:81]
    v_pk_fma_f32 v[82:83], v[42:43], v[72:73], v[82:83]
    v_pk_fma_f32 v[84:85], v[44:45], v[72:73], v[84:85]
    v_pk_fma_f32 v[86:87], v[46:47], v[72:73], v[86:87]
    v_pk_fma_f32 v[88:89], v[48:49], v[72:73], v[88:89]
    v_pk_fma_f32 v[90:91], v[50:51], v[72:73], v[90:91]
    v_pk_fma_f32 v[92:93], v[52:53], v[72:73], v[92:93]
    v_pk_fma_f32 v[94:95], v[54:55], v[72:73], v[94:95]
    s_waitcnt vmcnt(14)
    v_lshlrev_b32 v56, 16, v22
    v_and_b32 v57, 0xffff0000, v22
    s_waitcnt vmcnt(13)
    v_lshlrev_b32 v58, 16, v23
    v_and_b32 v59, 0xffff0000, v23
    s_waitcnt vmcnt(12)
    v_lshlrev_b32 v60, 16, v24
    v_and_b32 v61, 0xffff0000, v24
    s_waitcnt vmcnt(11)
    v_lshlrev_b32 v62, 16, v25
    v_and_b32 v63, 0xffff0000, v25
    s_waitcnt vmcnt(10)
    v_lshlrev_b32 v64, 16, v26
    v_and_b32 v65, 0xffff0000, v26
    s_waitcnt vmcnt(9)
    v_lshlrev_b32 v66, 16, v27
    v_and_b32 v67, 0xffff0000, v27
    s_waitcnt vmcnt(8)
    v_lshlrev_b32 v68, 16, v28
    v_and_b32 v69, 0xffff0000, v28
    s_waitcnt vmcnt(7)
    v_lshlrev_b32 v70, 16, v29
    v_and_b32 v71, 0xffff0000, v29
    v_pk_mul_f32 v[80:81], v[80:81], v[56:57]
    v_pk_mul_f32 v[82:83], v[82:83], v[58:59]
    v_pk_mul_f32 v[84:85], v[84:85], v[60:61]
    v_pk_mul_f32 v[86:87], v[86:87], v[62:63]
    v_pk_mul_f32 v[88:89], v[88:89], v[64:65]
    v_pk_mul_f32 v[90:91], v[90:91], v[66:67]
    v_pk_mul_f32 v[92:93], v[92:93], v[68:69]
    v_pk_mul_f32 v[94:95], v[94:95], v[70:71]
    v_cvt_pk_bf16_f32 v96, v94, v92
    v_cvt_pk_bf16_f32 v97, v90, v88
    v_cvt_pk_bf16_f32 v98, v86, v84
    v_cvt_pk_bf16_f32 v99, v82, v80
    buffer_store_dwordx4 v[96:99], v104, s[24:27], 0 offen sc1
    v_cvt_pk_bf16_f32 v100, v95, v93
    v_cvt_pk_bf16_f32 v101, v91, v89
    v_cvt_pk_bf16_f32 v102, v87, v85
    v_cvt_pk_bf16_f32 v103, v83, v81
    buffer_store_dwordx4 v[100:103], v104, s[24:27], s61 offen sc1
    s_mov_b64 s[48:49], s[72:73]
    s_mov_b32 s50, s44
    s_mov_b32 s51, 0x20000
    buffer_load_dword v112, v109, s[48:51], s45 offen
    s_mov_b32 s57, s55
    s_mul_i32 s62, s3, 176128
    s_add_u32 s24, s68, s62
    s_addc_u32 s25, s69, 0
    s_mov_b32 s26, 0x2b000
    s_mov_b32 s27, 0x20000
    s_lshl_b32 s66, s3, 10
    s_add_u32 s66, s66, 0x50000
    s_mov_b32 s46, 0xc0135761
    s_mov_b32 s47, 0xbdd2d3e8
    s_mov_b32 s54, 0x3b000000
    s_waitcnt lgkmcnt(0)
    s_mul_i32 s67, s67, 0x9e3779b1
    s_add_u32 s67, s67, 0x7f4a7c15
    v_mov_b32 v19, s67
    s_mul_i32 s73, s4, 12
    s_lshl_b32 s56, s4, 3
    s_add_u32 s56, s56, 22
    s_min_u32 s73, s73, s56
    s_lshl_b32 s64, s73, 5
    s_mul_i32 s56, s5, 11008
    s_add_u32 s64, s64, s56
    s_lshl2_add_u32 s58, s4, s5
    s_mul_i32 s59, s58, 3
    s_lshl_b32 s56, s58, 1
    s_add_u32 s56, s56, 22
    s_min_u32 s59, s59, s56
    s_sub_u32 s73, s59, s73
    s_add_u32 s56, s59, 0
    s_lshl_b32 s60, s56, 11
    s_add_u32 s56, s59, 1
    s_lshl_b32 s61, s56, 11
    s_add_u32 s56, s59, 2
    s_lshl_b32 s62, s56, 11
    s_cmp_lt_u32 s58, 22
    s_cselect_b32 s62, s62, 0x40000000
    v_lshlrev_b32 v5, 5, v1
    s_lshl_b32 s59, s7, 4
    v_add_u32 v5, s59, v5
    v_and_b32 v8, 15, v1
    v_lshrrev_b32 v7, 4, v1
    v_add_u32 v10, 1, v8
    v_and_b32 v11, 1, v10
    v_lshlrev_b32 v11, 4, v11
    v_bfe_u32 v12, v10, 1, 1
    v_mul_u32_u24 v12, 4224, v12
    v_and_b32 v10, 28, v10
    v_lshl_add_u32 v12, v10, 1, v12
    v_lshl_add_u32 v12, v7, 6, v12
    s_lshl_b32 s59, s7, 8
    s_mul_i32 s58, s6, 8448
    s_add_u32 s59, s59, s58
    v_add_u32 v12, s59, v12
    v_lshlrev_b32 v13, 1, v7
    v_sub_u32 v13, v13, v8
    s_mul_i32 s58, s6, 6144
    s_lshl_b32 s59, s7, 7
    s_add_u32 s59, s58, s59
    s_add_u32 s59, s59, 17136
    v_lshl_add_u32 v13, v13, 4, s59
    s_mul_i32 s59, s7, 3072
    s_add_u32 s55, s58, s59
    s_lshl_b32 s59, s5, 13
    s_add_u32 s59, s59, 29184
    v_add_u32 v4, s59, v2
    s_lshl_b32 s58, s5, 11
    s_add_u32 s59, s58, 29184
    v_add_u32 v15, s59, v2
    v_lshrrev_b32 v16, 1, v7
    v_mul_u32_u24 v16, 3072, v16
    v_lshl_add_u32 v16, v8, 4, v16
    v_and_b32 v17, 1, v7
    v_lshl_add_u32 v16, v17, 3, v16
    s_lshl_b32 s59, s5, 9
    s_sub_u32 s59, 21752, s59
    v_sub_u32 v16, s59, v16
    v_lshrrev_b32 v17, 2, v8
    v_mul_u32_u24 v17, 176128, v17
    v_and_b32 v10, 3, v8
    v_lshl_add_u32 v17, v10, 6, v17
    v_lshl_add_u32 v17, v7, 4, v17
    s_mul_i32 s58, s5, 1409024
    v_add_u32 v17, s58, v17
    v_lshl_add_u32 v10, v10, 2, v7
    v_lshrrev_b32 v6, 2, v8
    s_lshl_b32 s58, s5, 3
    v_add_u32 v6, s58, v6
    v_lshlrev_b32 v6, 12, v6
    v_add_u32 v6, 0x600008, v6
    v_add_u32 v18, 4088, v6
    v_cmp_eq_u32 s[70:71], 15, v10
    s_nop 1
    v_cndmask_b32 v6, v6, v18, s[70:71]
    v_cmp_eq_u32 vcc, 0, v10
    s_nop 0
    s_or_b64 vcc, vcc, s[70:71]
    v_mov_b32 v18, 0x40000000
    v_cndmask_b32 v18, v18, v6, vcc
    s_lshl_b32 s53, s76, 7
    s_and_b32 s76, s3, 3
    s_mov_b64 exec, 0xff
    s_waitcnt vmcnt(5)
    ds_write_b32 v107, v108
    s_mov_b64 exec, -1
    s_waitcnt lgkmcnt(0)
    s_barrier
    ds_read_b64 v[116:117], v12 offset:0
    ds_read_b64 v[118:119], v12 offset:8
    ds_read_b64 v[120:121], v12 offset:16
    ds_read_b64 v[122:123], v12 offset:24
    ds_read_b64 v[124:125], v12 offset:32
    ds_read_b64 v[126:127], v12 offset:40
    ds_read_b64 v[128:129], v12 offset:48
    ds_read_b64 v[130:131], v12 offset:56
    ds_read_b32 v244, v12 offset:64
    ds_read_b64 v[132:133], v12 offset:512
    ds_read_b64 v[134:135], v12 offset:520
    ds_read_b64 v[136:137], v12 offset:528
    ds_read_b64 v[138:139], v12 offset:536
    ds_read_b64 v[140:141], v12 offset:544
    ds_read_b64 v[142:143], v12 offset:552
    ds_read_b64 v[144:145], v12 offset:560
    ds_read_b64 v[146:147], v12 offset:568
    ds_read_b32 v245, v12 offset:576
    s_waitcnt lgkmcnt(14)
    v_alignbit_b32 v116, v117, v116, v11
    ds_read_b64 v[148:149], v12 offset:1024
    v_alignbit_b32 v117, v118, v117, v11
    ds_read_b64 v[150:151], v12 offset:1032
    v_alignbit_b32 v118, v119, v118, v11
    ds_read_b64 v[152:153], v12 offset:1040
    v_alignbit_b32 v119, v120, v119, v11
    ds_read_b64 v[154:155], v12 offset:1048
    v_alignbit_b32 v120, v121, v120, v11
    ds_read_b64 v[156:157], v12 offset:1056
    v_alignbit_b32 v121, v122, v121, v11
    ds_read_b64 v[158:159], v12 offset:1064
    v_alignbit_b32 v122, v123, v122, v11
    ds_read_b64 v[160:161], v12 offset:1072
    s_waitcnt lgkmcnt(14)
    v_alignbit_b32 v123, v124, v123, v11
    ds_read_b64 v[162:163], v12 offset:1080
    v_alignbit_b32 v124, v125, v124, v11
    ds_read_b32 v246, v12 offset:1088
    v_alignbit_b32 v125, v126, v125, v11
    v_alignbit_b32 v126, v127, v126, v11
    v_alignbit_b32 v127, v128, v127, v11
    v_alignbit_b32 v128, v129, v128, v11
    v_alignbit_b32 v129, v130, v129, v11
    v_alignbit_b32 v130, v131, v130, v11
    v_alignbit_b32 v131, v244, v131, v11
    v_alignbit_b32 v132, v133, v132, v11
    ds_read_b64 v[164:165], v12 offset:1536
    v_alignbit_b32 v133, v134, v133, v11
    ds_read_b64 v[166:167], v12 offset:1544
    v_alignbit_b32 v134, v135, v134, v11
    ds_read_b64 v[168:169], v12 offset:1552
    s_waitcnt lgkmcnt(14)
    v_alignbit_b32 v135, v136, v135, v11
    ds_read_b64 v[170:171], v12 offset:1560
    v_alignbit_b32 v136, v137, v136, v11
    ds_read_b64 v[172:173], v12 offset:1568
    v_alignbit_b32 v137, v138, v137, v11
    ds_read_b64 v[174:175], v12 offset:1576
    v_alignbit_b32 v138, v139, v138, v11
    ds_read_b64 v[176:177], v12 offset:1584
    v_alignbit_b32 v139, v140, v139, v11
    ds_read_b64 v[178:179], v12 offset:1592
    v_alignbit_b32 v140, v141, v140, v11
    ds_read_b32 v247, v12 offset:1600
    v_alignbit_b32 v141, v142, v141, v11
    v_alignbit_b32 v142, v143, v142, v11
    v_alignbit_b32 v143, v144, v143, v11
    v_alignbit_b32 v144, v145, v144, v11
    s_waitcnt lgkmcnt(14)
    v_alignbit_b32 v145, v146, v145, v11
    v_alignbit_b32 v146, v147, v146, v11
    v_alignbit_b32 v147, v245, v147, v11
    v_alignbit_b32 v148, v149, v148, v11
    ds_read_b64 v[180:181], v12 offset:2048
    v_alignbit_b32 v149, v150, v149, v11
    ds_read_b64 v[182:183], v12 offset:2056
    v_alignbit_b32 v150, v151, v150, v11
    ds_read_b64 v[184:185], v12 offset:2064
    v_alignbit_b32 v151, v152, v151, v11
    ds_read_b64 v[186:187], v12 offset:2072
    v_alignbit_b32 v152, v153, v152, v11
    ds_read_b64 v[188:189], v12 offset:2080
    v_alignbit_b32 v153, v154, v153, v11
    ds_read_b64 v[190:191], v12 offset:2088
    v_alignbit_b32 v154, v155, v154, v11
    ds_read_b64 v[192:193], v12 offset:2096
    s_waitcnt lgkmcnt(14)
    v_alignbit_b32 v155, v156, v155, v11
    ds_read_b64 v[194:195], v12 offset:2104
    v_alignbit_b32 v156, v157, v156, v11
    ds_read_b32 v248, v12 offset:2112
    s_nop 0
    v_alignbit_b32 v157, v158, v157, v11
    v_alignbit_b32 v158, v159, v158, v11
    v_alignbit_b32 v159, v160, v159, v11
    v_alignbit_b32 v160, v161, v160, v11
    v_alignbit_b32 v161, v162, v161, v11
    v_alignbit_b32 v162, v163, v162, v11
    v_alignbit_b32 v163, v246, v163, v11
    v_alignbit_b32 v164, v165, v164, v11
    ds_read_b64 v[196:197], v12 offset:2560
    v_alignbit_b32 v165, v166, v165, v11
    ds_read_b64 v[198:199], v12 offset:2568
    v_alignbit_b32 v166, v167, v166, v11
    ds_read_b64 v[200:201], v12 offset:2576
    s_waitcnt lgkmcnt(14)
    v_alignbit_b32 v167, v168, v167, v11
    ds_read_b64 v[202:203], v12 offset:2584
    v_alignbit_b32 v168, v169, v168, v11
    ds_read_b64 v[204:205], v12 offset:2592
    v_alignbit_b32 v169, v170, v169, v11
    ds_read_b64 v[206:207], v12 offset:2600
    v_alignbit_b32 v170, v171, v170, v11
    ds_read_b64 v[208:209], v12 offset:2608
    v_alignbit_b32 v171, v172, v171, v11
    ds_read_b64 v[210:211], v12 offset:2616
    v_alignbit_b32 v172, v173, v172, v11
    ds_read_b32 v249, v12 offset:2624
    v_alignbit_b32 v173, v174, v173, v11
    v_alignbit_b32 v174, v175, v174, v11
    v_alignbit_b32 v175, v176, v175, v11
    v_alignbit_b32 v176, v177, v176, v11
    s_waitcnt lgkmcnt(14)
    v_alignbit_b32 v177, v178, v177, v11
    v_alignbit_b32 v178, v179, v178, v11
    v_alignbit_b32 v179, v247, v179, v11
    v_mov_b32 v254, v110
    v_mov_b32 v255, v111
    s_waitcnt vmcnt(1)
    s_barrier
    s_cmp_lg_u32 s5, 0
    s_cbranch_scc1 W0_1
    s_lshl2_add_u32 s59, s77, s53
    s_add_u32 s59, s59, 0x58c00
    s_lshl3_add_u32 s58, s77, s57
    s_waitcnt vmcnt(0)
    v_mov_b32 v112, s67
    v_mov_b32 v113, s74
    s_mov_b64 exec, 1
    buffer_store_dword v19, off, s[36:39], s59
    buffer_store_dwordx2 v[112:113], off, s[36:39], s58 sc1
    s_mov_b64 exec, -1
W0_1:
    s_mov_b32 s52, s74
    v_alignbit_b32 v180, v181, v180, v11
    ds_read_b64 v[212:213], v12 offset:3072
    v_alignbit_b32 v181, v182, v181, v11
    ds_read_b64 v[214:215], v12 offset:3080
    v_alignbit_b32 v182, v183, v182, v11
    ds_read_b64 v[216:217], v12 offset:3088
    v_alignbit_b32 v183, v184, v183, v11
    ds_read_b64 v[218:219], v12 offset:3096
    v_alignbit_b32 v184, v185, v184, v11
    ds_read_b64 v[220:221], v12 offset:3104
    v_alignbit_b32 v185, v186, v185, v11
    ds_read_b64 v[222:223], v12 offset:3112
    v_alignbit_b32 v186, v187, v186, v11
    ds_read_b64 v[224:225], v12 offset:3120
    s_waitcnt lgkmcnt(14)
    v_alignbit_b32 v187, v188, v187, v11
    ds_read_b64 v[226:227], v12 offset:3128
    v_alignbit_b32 v188, v189, v188, v11
    ds_read_b32 v250, v12 offset:3136
    s_nop 0
    v_alignbit_b32 v189, v190, v189, v11
    v_alignbit_b32 v190, v191, v190, v11
    v_alignbit_b32 v191, v192, v191, v11
    v_alignbit_b32 v192, v193, v192, v11
    v_alignbit_b32 v193, v194, v193, v11
    v_alignbit_b32 v194, v195, v194, v11
    v_alignbit_b32 v195, v248, v195, v11
    v_alignbit_b32 v196, v197, v196, v11
    ds_read_b64 v[228:229], v12 offset:3584
    v_alignbit_b32 v197, v198, v197, v11
    ds_read_b64 v[230:231], v12 offset:3592
    v_alignbit_b32 v198, v199, v198, v11
    ds_read_b64 v[232:233], v12 offset:3600
    s_waitcnt lgkmcnt(14)
    v_alignbit_b32 v199, v200, v199, v11
    ds_read_b64 v[234:235], v12 offset:3608
    v_alignbit_b32 v200, v201, v200, v11
    ds_read_b64 v[236:237], v12 offset:3616
    v_alignbit_b32 v201, v202, v201, v11
    ds_read_b64 v[238:239], v12 offset:3624
    v_alignbit_b32 v202, v203, v202, v11
    ds_read_b64 v[240:241], v12 offset:3632
    v_alignbit_b32 v203, v204, v203, v11
    ds_read_b64 v[242:243], v12 offset:3640
    v_alignbit_b32 v204, v205, v204, v11
    ds_read_b32 v251, v12 offset:3648
    v_alignbit_b32 v205, v206, v205, v11
    v_alignbit_b32 v206, v207, v206, v11
    v_alignbit_b32 v207, v208, v207, v11
    v_alignbit_b32 v208, v209, v208, v11
    s_waitcnt lgkmcnt(14)
    v_alignbit_b32 v209, v210, v209, v11
    v_alignbit_b32 v210, v211, v210, v11
    v_alignbit_b32 v211, v249, v211, v11
    v_alignbit_b32 v212, v213, v212, v11
    v_alignbit_b32 v213, v214, v213, v11
    v_alignbit_b32 v214, v215, v214, v11
    v_alignbit_b32 v215, v216, v215, v11
    v_alignbit_b32 v216, v217, v216, v11
    v_alignbit_b32 v217, v218, v217, v11
    v_alignbit_b32 v218, v219, v218, v11
    s_waitcnt lgkmcnt(13)
    v_alignbit_b32 v219, v220, v219, v11
    v_alignbit_b32 v220, v221, v220, v11
    s_waitcnt lgkmcnt(12)
    v_alignbit_b32 v221, v222, v221, v11
    v_alignbit_b32 v222, v223, v222, v11
    s_waitcnt lgkmcnt(11)
    v_alignbit_b32 v223, v224, v223, v11
    v_alignbit_b32 v224, v225, v224, v11
    s_waitcnt lgkmcnt(10)
    v_alignbit_b32 v225, v226, v225, v11
    v_alignbit_b32 v226, v227, v226, v11
    s_waitcnt lgkmcnt(9)
    v_alignbit_b32 v227, v250, v227, v11
    s_add_u32 s59, s53, 0x58c00
    s_cmp_lg_u32 s5, 0
    s_cbranch_scc1 W0_2
    s_mov_b32 s49, 0
E1P_3:
    buffer_load_dword v14, v3, s[36:39], s59 offen sc1
    s_waitcnt vmcnt(0)
    v_cmp_ne_u32 vcc, s67, v14
    s_nop 0
    s_cbranch_vccz E1E_4
    s_add_u32 s49, s49, 1
    s_and_b32 s48, s49, 7
    s_cbranch_scc1 E1P_3
    buffer_load_dword v14, v9, s[36:39], s57 offen sc1
    s_cmp_gt_u32 s49, 0x200000
    s_cbranch_scc1 E1E_4
    s_waitcnt vmcnt(0)
    v_cmp_ne_u32 vcc, s67, v14
    s_nop 0
    s_cbranch_vccnz E1P_3
E1E_4:
    s_waitcnt vmcnt(0)
W0_2:
    s_barrier
    s_add_u32 m0, s55, 16896
    s_movk_i32 s58, 0x400
    s_movk_i32 s59, 0x800
    buffer_load_dwordx4 v5, s[32:35], 0 offen sc1 lds
    buffer_load_dwordx4 v5, s[32:35], s58 offen offset:1024 sc1 lds
    buffer_load_dwordx4 v5, s[32:35], s59 offen offset:2048 sc1 lds
    s_waitcnt lgkmcnt(8)
    v_alignbit_b32 v228, v229, v228, v11
    s_waitcnt lgkmcnt(7)
    v_alignbit_b32 v229, v230, v229, v11
    v_alignbit_b32 v230, v231, v230, v11
    s_waitcnt lgkmcnt(6)
    v_alignbit_b32 v231, v232, v231, v11
    v_alignbit_b32 v232, v233, v232, v11
    s_waitcnt lgkmcnt(5)
    v_alignbit_b32 v233, v234, v233, v11
    v_alignbit_b32 v234, v235, v234, v11
    s_waitcnt lgkmcnt(4)
    v_alignbit_b32 v235, v236, v235, v11
    v_alignbit_b32 v236, v237, v236, v11
    s_waitcnt lgkmcnt(3)
    v_alignbit_b32 v237, v238, v237, v11
    v_alignbit_b32 v238, v239, v238, v11
    s_waitcnt lgkmcnt(2)
    v_alignbit_b32 v239, v240, v239, v11
    v_alignbit_b32 v240, v241, v240, v11
    s_waitcnt lgkmcnt(1)
    v_alignbit_b32 v241, v242, v241, v11
    v_alignbit_b32 v242, v243, v242, v11
    s_waitcnt lgkmcnt(0)
    v_alignbit_b32 v243, v251, v243, v11
    v_mov_b32 v251, v9
    v_bfe_u32 v6, v1, 4, 1
    v_bfe_u32 v9, v1, 2, 2
    v_lshl_add_u32 v6, v6, 2, v9
    v_lshrrev_b32 v9, 1, v6
    v_add_u32 v9, s73, v9
    v_mul_u32_u24 v6, 384, v6
    v_and_b32 v10, 3, v1
    v_lshl_add_u32 v6, v10, 3, v6
    v_lshrrev_b32 v10, 5, v1
    v_mul_u32_u24 v10, 49152, v10
    v_add_u32 v6, 65536, v6
    v_add_u32 v6, v6, v10
    v_add_u32 v10, 0, v9
    v_subrev_u32 v14, 12, v10
    v_min_u32 v10, v10, v14
    v_lshl_add_u32 v244, v10, 5, v6
    v_add_u32 v10, 1, v9
    v_subrev_u32 v14, 12, v10
    v_min_u32 v10, v10, v14
    v_lshl_add_u32 v245, v10, 5, v6
    v_add_u32 v10, 2, v9
    v_subrev_u32 v14, 12, v10
    v_min_u32 v10, v10, v14
    v_lshl_add_u32 v246, v10, 5, v6
    s_lshl_b32 s58, s4, 2
    s_sub_u32 s58, 40, s58
    s_max_u32 s58, s58, 16
    s_min_u32 s58, s58, 24
    v_add_u32 v6, 0, v1
    v_mul_u32_u24 v9, 43691, v6
    v_lshrrev_b32 v9, 20, v9
    v_mul_u32_u24 v10, 24, v9
    v_sub_u32 v6, v6, v10
    v_and_b32 v10, 6, v9
    v_sub_u32 v6, v6, v10
    v_add_u32 v10, 24, v6
    v_min_u32 v6, v6, v10
    v_and_b32 v10, 3, v9
    v_lshrrev_b32 v9, 2, v9
    v_lshl_add_u32 v10, v9, 4, v10
    v_mul_u32_u24 v10, 2752, v10
    v_lshl_add_u32 v10, v6, 4, v10
    v_cmp_gt_u32 vcc, s58, v6
    v_mov_b32 v9, 0x40000000
    s_nop 0
    v_cndmask_b32 v248, v9, v10, vcc
    v_add_u32 v6, 64, v1
    v_mul_u32_u24 v9, 43691, v6
    v_lshrrev_b32 v9, 20, v9
    v_mul_u32_u24 v10, 24, v9
    v_sub_u32 v6, v6, v10
    v_and_b32 v10, 6, v9
    v_sub_u32 v6, v6, v10
    v_add_u32 v10, 24, v6
    v_min_u32 v6, v6, v10
    v_and_b32 v10, 3, v9
    v_lshrrev_b32 v9, 2, v9
    v_lshl_add_u32 v10, v9, 4, v10
    v_mul_u32_u24 v10, 2752, v10
    v_lshl_add_u32 v10, v6, 4, v10
    v_subrev_u32 v10, 1024, v10
    v_cmp_gt_u32 vcc, s58, v6
    v_mov_b32 v9, 0x40000000
    s_nop 0
    v_cndmask_b32 v249, v9, v10, vcc
    v_add_u32 v6, 128, v1
    v_mul_u32_u24 v9, 43691, v6
    v_lshrrev_b32 v9, 20, v9
    v_mul_u32_u24 v10, 24, v9
    v_sub_u32 v6, v6, v10
    v_and_b32 v10, 6, v9
    v_sub_u32 v6, v6, v10
    v_add_u32 v10, 24, v6
    v_min_u32 v6, v6, v10
    v_and_b32 v10, 3, v9
    v_lshrrev_b32 v9, 2, v9
    v_lshl_add_u32 v10, v9, 4, v10
    v_mul_u32_u24 v10, 2752, v10
    v_lshl_add_u32 v10, v6, 4, v10
    v_subrev_u32 v10, 2048, v10
    v_cmp_gt_u32 vcc, s58, v6
    v_mov_b32 v9, 0x40000000
    s_nop 0
    v_cndmask_b32 v250, v9, v10, vcc
    v_lshrrev_b32 v6, 5, v1
    v_lshl_add_u32 v247, v6, 13, v252
    s_mov_b32 s32, s68
    s_mov_b32 s33, s69
    s_mov_b32 s34, 0xf20000
    s_mov_b32 s35, 0x20000
    s_mov_b32 s74, s76
    s_mul_i32 s50, s74, 88064
    s_add_u32 s50, s50, s64
    s_mul_i32 s51, s74, 3072
    s_add_u32 s51, s51, s65
    s_add_u32 m0, s51, 0
    s_nop 0
    buffer_load_dwordx4 v248, s[28:31], s50 offen offset:0 lds
    buffer_load_dwordx4 v249, s[28:31], s50 offen offset:1024 lds
    buffer_load_dwordx4 v250, s[28:31], s50 offen offset:2048 lds
    s_waitcnt vmcnt(3)
    s_barrier
    ds_read_b128 v[52:55], v13 offset:1792
    ds_read_b128 v[56:59], v13 offset:1536
    ds_read_b128 v[60:63], v13 offset:1280
    ds_read_b128 v[64:67], v13 offset:1024
    ds_read_b128 v[68:71], v13 offset:768
    ds_read_b128 v[72:75], v13 offset:512
    ds_read_b128 v[76:79], v13 offset:256
    ds_read_b128 v[80:83], v13 offset:0
    s_waitcnt lgkmcnt(7)
    v_mfma_f32_16x16x32_bf16 v[20:23], v[116:119], v[52:55], 0
    s_add_u32 s74, s74, 1
    s_and_b32 s74, s74, 3
    v_mfma_f32_16x16x32_bf16 v[24:27], v[132:135], v[52:55], 0
    ds_read_b128 v[84:87], v13 offset:4864
    s_mul_i32 s50, s74, 88064
    v_mfma_f32_16x16x32_bf16 v[28:31], v[148:151], v[52:55], 0
    s_add_u32 s50, s50, s64
    s_mul_i32 s51, s74, 3072
    v_mfma_f32_16x16x32_bf16 v[32:35], v[164:167], v[52:55], 0
    ds_read_b128 v[88:91], v13 offset:4608
    s_add_u32 s51, s51, s65
    v_mfma_f32_16x16x32_bf16 v[36:39], v[180:183], v[52:55], 0
    s_add_u32 m0, s51, 0
    s_nop 0
    buffer_load_dwordx4 v248, s[28:31], s50 offen offset:0 lds
    v_mfma_f32_16x16x32_bf16 v[40:43], v[196:199], v[52:55], 0
    ds_read_b128 v[92:95], v13 offset:4352
    v_mfma_f32_16x16x32_bf16 v[44:47], v[212:215], v[52:55], 0
    v_mfma_f32_16x16x32_bf16 v[48:51], v[228:231], v[52:55], 0
    ds_read_b128 v[96:99], v13 offset:4096
    buffer_load_dwordx4 v249, s[28:31], s50 offen offset:1024 lds
    s_waitcnt lgkmcnt(10)
    v_mfma_f32_16x16x32_bf16 v[24:27], v[116:119], v[56:59], v[24:27]
    v_mfma_f32_16x16x32_bf16 v[28:31], v[132:135], v[56:59], v[28:31]
    ds_read_b128 v[100:103], v13 offset:3840
    v_mfma_f32_16x16x32_bf16 v[32:35], v[148:151], v[56:59], v[32:35]
    buffer_load_dwordx4 v250, s[28:31], s50 offen offset:2048 lds
    s_add_u32 s74, s74, 1
    v_mfma_f32_16x16x32_bf16 v[36:39], v[164:167], v[56:59], v[36:39]
    ds_read_b128 v[104:107], v13 offset:3584
    s_and_b32 s74, s74, 3
    v_mfma_f32_16x16x32_bf16 v[40:43], v[180:183], v[56:59], v[40:43]
    s_mul_i32 s50, s74, 88064
    s_add_u32 s50, s50, s64
    v_mfma_f32_16x16x32_bf16 v[44:47], v[196:199], v[56:59], v[44:47]
    ds_read_b128 v[108:111], v13 offset:3328
    s_mul_i32 s51, s74, 3072
    v_mfma_f32_16x16x32_bf16 v[48:51], v[212:215], v[56:59], v[48:51]
    s_add_u32 s51, s51, s65
    s_add_u32 m0, s51, 0
    s_waitcnt lgkmcnt(12)
    v_mfma_f32_16x16x32_bf16 v[28:31], v[116:119], v[60:63], v[28:31]
    ds_read_b128 v[112:115], v13 offset:3072
    buffer_load_dwordx4 v248, s[28:31], s50 offen offset:0 lds
    v_mfma_f32_16x16x32_bf16 v[32:35], v[132:135], v[60:63], v[32:35]
    v_mfma_f32_16x16x32_bf16 v[36:39], v[148:151], v[60:63], v[36:39]
    v_mfma_f32_16x16x32_bf16 v[40:43], v[164:167], v[60:63], v[40:43]
    buffer_load_dwordx4 v249, s[28:31], s50 offen offset:1024 lds
    v_mfma_f32_16x16x32_bf16 v[44:47], v[180:183], v[60:63], v[44:47]
    v_mfma_f32_16x16x32_bf16 v[48:51], v[196:199], v[60:63], v[48:51]
    s_waitcnt lgkmcnt(12)
    v_mfma_f32_16x16x32_bf16 v[32:35], v[116:119], v[64:67], v[32:35]
    buffer_load_dwordx4 v250, s[28:31], s50 offen offset:2048 lds
    s_add_u32 s74, s74, 1
    v_mfma_f32_16x16x32_bf16 v[36:39], v[132:135], v[64:67], v[36:39]
    s_and_b32 s74, s74, 3
    s_mul_i32 s50, s74, 88064
    v_mfma_f32_16x16x32_bf16 v[40:43], v[148:151], v[64:67], v[40:43]
    s_add_u32 s50, s50, s64
    s_mul_i32 s51, s74, 3072
    v_mfma_f32_16x16x32_bf16 v[44:47], v[164:167], v[64:67], v[44:47]
    s_add_u32 s51, s51, s65
    s_add_u32 m0, s51, 0
    v_mfma_f32_16x16x32_bf16 v[48:51], v[180:183], v[64:67], v[48:51]
    buffer_load_dwordx4 v248, s[28:31], s50 offen offset:0 lds
    s_waitcnt lgkmcnt(11)
    v_mfma_f32_16x16x32_bf16 v[36:39], v[116:119], v[68:71], v[36:39]
    v_mfma_f32_16x16x32_bf16 v[40:43], v[132:135], v[68:71], v[40:43]
    v_mfma_f32_16x16x32_bf16 v[44:47], v[148:151], v[68:71], v[44:47]
    buffer_load_dwordx4 v249, s[28:31], s50 offen offset:1024 lds
    v_mfma_f32_16x16x32_bf16 v[48:51], v[164:167], v[68:71], v[48:51]
    s_waitcnt lgkmcnt(10)
    v_mfma_f32_16x16x32_bf16 v[40:43], v[116:119], v[72:75], v[40:43]
    v_mfma_f32_16x16x32_bf16 v[44:47], v[132:135], v[72:75], v[44:47]
    buffer_load_dwordx4 v250, s[28:31], s50 offen offset:2048 lds
    s_mov_b32 s74, s76
    v_mfma_f32_16x16x32_bf16 v[48:51], v[148:151], v[72:75], v[48:51]
    s_mul_i32 s50, s74, 88064
    s_add_u32 s50, s50, s64
    s_waitcnt lgkmcnt(9)
    v_mfma_f32_16x16x32_bf16 v[44:47], v[116:119], v[76:79], v[44:47]
    s_mul_i32 s51, s74, 3072
    s_add_u32 s51, s51, s65
    v_mfma_f32_16x16x32_bf16 v[48:51], v[132:135], v[76:79], v[48:51]
    s_add_u32 s50, s50, 352256
    s_add_u32 m0, s51, 12288
    s_waitcnt lgkmcnt(8)
    v_mfma_f32_16x16x32_bf16 v[48:51], v[116:119], v[80:83], v[48:51]
    buffer_load_dwordx4 v248, s[28:31], s50 offen offset:0 lds
    s_waitcnt lgkmcnt(7)
    v_mfma_f32_16x16x32_bf16 v[20:23], v[120:123], v[84:87], v[20:23]
    v_mfma_f32_16x16x32_bf16 v[24:27], v[136:139], v[84:87], v[24:27]
    ds_read_b128 v[52:55], v13 offset:1808
    v_mfma_f32_16x16x32_bf16 v[28:31], v[152:155], v[84:87], v[28:31]
    buffer_load_dwordx4 v249, s[28:31], s50 offen offset:1024 lds
    v_mfma_f32_16x16x32_bf16 v[32:35], v[168:171], v[84:87], v[32:35]
    ds_read_b128 v[56:59], v13 offset:1552
    v_mfma_f32_16x16x32_bf16 v[36:39], v[184:187], v[84:87], v[36:39]
    v_mfma_f32_16x16x32_bf16 v[40:43], v[200:203], v[84:87], v[40:43]
    ds_read_b128 v[60:63], v13 offset:1296
    buffer_load_dwordx4 v250, s[28:31], s50 offen offset:2048 lds
    v_mfma_f32_16x16x32_bf16 v[44:47], v[216:219], v[84:87], v[44:47]
    s_add_u32 s74, s74, 1
    s_and_b32 s74, s74, 3
    v_mfma_f32_16x16x32_bf16 v[48:51], v[232:235], v[84:87], v[48:51]
    ds_read_b128 v[64:67], v13 offset:1040
    s_mul_i32 s50, s74, 88064
    s_waitcnt lgkmcnt(10)
    v_mfma_f32_16x16x32_bf16 v[24:27], v[120:123], v[88:91], v[24:27]
    s_add_u32 s50, s50, s64
    s_mul_i32 s51, s74, 3072
    v_mfma_f32_16x16x32_bf16 v[28:31], v[136:139], v[88:91], v[28:31]
    ds_read_b128 v[68:71], v13 offset:784
    s_add_u32 s51, s51, s65
    v_mfma_f32_16x16x32_bf16 v[32:35], v[152:155], v[88:91], v[32:35]
    s_add_u32 s50, s50, 352256
    s_add_u32 m0, s51, 12288
    v_mfma_f32_16x16x32_bf16 v[36:39], v[168:171], v[88:91], v[36:39]
    ds_read_b128 v[72:75], v13 offset:528
    buffer_load_dwordx4 v248, s[28:31], s50 offen offset:0 lds
    v_mfma_f32_16x16x32_bf16 v[40:43], v[184:187], v[88:91], v[40:43]
    v_mfma_f32_16x16x32_bf16 v[44:47], v[200:203], v[88:91], v[44:47]
    ds_read_b128 v[76:79], v13 offset:272
    v_mfma_f32_16x16x32_bf16 v[48:51], v[216:219], v[88:91], v[48:51]
    buffer_load_dwordx4 v249, s[28:31], s50 offen offset:1024 lds
    s_waitcnt lgkmcnt(12)
    v_mfma_f32_16x16x32_bf16 v[28:31], v[120:123], v[92:95], v[28:31]
    ds_read_b128 v[80:83], v13 offset:16
    v_mfma_f32_16x16x32_bf16 v[32:35], v[136:139], v[92:95], v[32:35]
    v_mfma_f32_16x16x32_bf16 v[36:39], v[152:155], v[92:95], v[36:39]
    buffer_load_dwordx4 v250, s[28:31], s50 offen offset:2048 lds
    s_add_u32 s74, s74, 1
    v_mfma_f32_16x16x32_bf16 v[40:43], v[168:171], v[92:95], v[40:43]
    s_and_b32 s74, s74, 3
    s_mul_i32 s50, s74, 88064
    v_mfma_f32_16x16x32_bf16 v[44:47], v[184:187], v[92:95], v[44:47]
    s_add_u32 s50, s50, s64
    s_mul_i32 s51, s74, 3072
    v_mfma_f32_16x16x32_bf16 v[48:51], v[200:203], v[92:95], v[48:51]
    s_add_u32 s51, s51, s65
    s_add_u32 s50, s50, 352256
    s_waitcnt lgkmcnt(12)
    v_mfma_f32_16x16x32_bf16 v[32:35], v[120:123], v[96:99], v[32:35]
    s_add_u32 m0, s51, 12288
    s_nop 0
    buffer_load_dwordx4 v248, s[28:31], s50 offen offset:0 lds
    v_mfma_f32_16x16x32_bf16 v[36:39], v[136:139], v[96:99], v[36:39]
    v_mfma_f32_16x16x32_bf16 v[40:43], v[152:155], v[96:99], v[40:43]
    v_mfma_f32_16x16x32_bf16 v[44:47], v[168:171], v[96:99], v[44:47]
    buffer_load_dwordx4 v249, s[28:31], s50 offen offset:1024 lds
    v_mfma_f32_16x16x32_bf16 v[48:51], v[184:187], v[96:99], v[48:51]
    s_waitcnt lgkmcnt(11)
    v_mfma_f32_16x16x32_bf16 v[36:39], v[120:123], v[100:103], v[36:39]
    v_mfma_f32_16x16x32_bf16 v[40:43], v[136:139], v[100:103], v[40:43]
    buffer_load_dwordx4 v250, s[28:31], s50 offen offset:2048 lds
    s_add_u32 s74, s74, 1
    v_mfma_f32_16x16x32_bf16 v[44:47], v[152:155], v[100:103], v[44:47]
    s_and_b32 s74, s74, 3
    s_mul_i32 s50, s74, 88064
    v_mfma_f32_16x16x32_bf16 v[48:51], v[168:171], v[100:103], v[48:51]
    s_add_u32 s50, s50, s64
    s_mul_i32 s51, s74, 3072
    s_waitcnt lgkmcnt(10)
    v_mfma_f32_16x16x32_bf16 v[40:43], v[120:123], v[104:107], v[40:43]
    s_add_u32 s51, s51, s65
    s_add_u32 s50, s50, 352256
    v_mfma_f32_16x16x32_bf16 v[44:47], v[136:139], v[104:107], v[44:47]
    s_add_u32 m0, s51, 12288
    s_nop 0
    buffer_load_dwordx4 v248, s[28:31], s50 offen offset:0 lds
    v_mfma_f32_16x16x32_bf16 v[48:51], v[152:155], v[104:107], v[48:51]
    s_waitcnt lgkmcnt(9)
    v_mfma_f32_16x16x32_bf16 v[44:47], v[120:123], v[108:111], v[44:47]
    v_mfma_f32_16x16x32_bf16 v[48:51], v[136:139], v[108:111], v[48:51]
    buffer_load_dwordx4 v249, s[28:31], s50 offen offset:1024 lds
    s_waitcnt lgkmcnt(8)
    v_mfma_f32_16x16x32_bf16 v[48:51], v[120:123], v[112:115], v[48:51]
    s_waitcnt lgkmcnt(7)
    v_mfma_f32_16x16x32_bf16 v[20:23], v[124:127], v[52:55], v[20:23]
    v_mfma_f32_16x16x32_bf16 v[24:27], v[140:143], v[52:55], v[24:27]
    ds_read_b128 v[84:87], v13 offset:4880
    buffer_load_dwordx4 v250, s[28:31], s50 offen offset:2048 lds
    v_mfma_f32_16x16x32_bf16 v[28:31], v[156:159], v[52:55], v[28:31]
    v_mfma_f32_16x16x32_bf16 v[32:35], v[172:175], v[52:55], v[32:35]
    ds_read_b128 v[88:91], v13 offset:4624
    v_mfma_f32_16x16x32_bf16 v[36:39], v[188:191], v[52:55], v[36:39]
    buffer_load_dword v10, v254, s[8:11], 0 offen
    v_mfma_f32_16x16x32_bf16 v[40:43], v[204:207], v[52:55], v[40:43]
    s_waitcnt vmcnt(13)
    s_barrier
    ds_read_b128 v[92:95], v13 offset:4368
    v_mfma_f32_16x16x32_bf16 v[44:47], v[220:223], v[52:55], v[44:47]
    ds_read_b64_tr_b16 a[64:65], v244 offset:0
    ds_read_b64_tr_b16 a[66:67], v244 offset:24576
    v_mfma_f32_16x16x32_bf16 v[48:51], v[236:239], v[52:55], v[48:51]
    ds_read_b128 v[96:99], v13 offset:4112
    ds_read_b64_tr_b16 a[128:129], v245 offset:0
    s_waitcnt lgkmcnt(13)
    v_mfma_f32_16x16x32_bf16 v[24:27], v[124:127], v[56:59], v[24:27]
    ds_read_b64_tr_b16 a[130:131], v245 offset:24576
    ds_read_b64_tr_b16 a[192:193], v246 offset:0
    v_mfma_f32_16x16x32_bf16 v[28:31], v[140:143], v[56:59], v[28:31]
    ds_read_b128 v[100:103], v13 offset:3856
    ds_read_b64_tr_b16 a[194:195], v246 offset:24576
    v_mfma_f32_16x16x32_bf16 v[32:35], v[156:159], v[56:59], v[32:35]
    ds_read_b64_tr_b16 a[68:69], v244 offset:3072
    ds_read_b64_tr_b16 a[70:71], v244 offset:27648
    v_mfma_f32_16x16x32_bf16 v[36:39], v[172:175], v[56:59], v[36:39]
    ds_read_b128 v[104:107], v13 offset:3600
    ds_read_b64_tr_b16 a[132:133], v245 offset:3072
    v_mfma_f32_16x16x32_bf16 v[40:43], v[188:191], v[56:59], v[40:43]
    ds_read_b64_tr_b16 a[134:135], v245 offset:27648
    ds_read_b64_tr_b16 a[196:197], v246 offset:3072
    v_mfma_f32_16x16x32_bf16 v[44:47], v[204:207], v[56:59], v[44:47]
    ds_read_b128 v[108:111], v13 offset:3344
    ds_read_b64_tr_b16 a[198:199], v246 offset:27648
    v_mfma_f32_16x16x32_bf16 v[48:51], v[220:223], v[56:59], v[48:51]
    ds_read_b64_tr_b16 a[72:73], v244 offset:6144
    ds_read_b64_tr_b16 a[74:75], v244 offset:30720
    s_waitcnt lgkmcnt(14)
    v_mfma_f32_16x16x32_bf16 v[28:31], v[124:127], v[60:63], v[28:31]
    ds_read_b128 v[112:115], v13 offset:3088
    ds_read_b64_tr_b16 a[136:137], v245 offset:6144
    v_mfma_f32_16x16x32_bf16 v[32:35], v[140:143], v[60:63], v[32:35]
    ds_read_b64_tr_b16 a[138:139], v245 offset:30720
    ds_read_b64_tr_b16 a[200:201], v246 offset:6144
    v_mfma_f32_16x16x32_bf16 v[36:39], v[156:159], v[60:63], v[36:39]
    ds_read_b64_tr_b16 a[202:203], v246 offset:30720
    ds_read_b64_tr_b16 a[76:77], v244 offset:9216
    v_mfma_f32_16x16x32_bf16 v[40:43], v[172:175], v[60:63], v[40:43]
    ds_read_b64_tr_b16 a[78:79], v244 offset:33792
    ds_read_b64_tr_b16 a[140:141], v245 offset:9216
    v_mfma_f32_16x16x32_bf16 v[44:47], v[188:191], v[60:63], v[44:47]
    ds_read_b64_tr_b16 a[142:143], v245 offset:33792
    ds_read_b64_tr_b16 a[204:205], v246 offset:9216
    v_mfma_f32_16x16x32_bf16 v[48:51], v[204:207], v[60:63], v[48:51]
    ds_read_b64_tr_b16 a[206:207], v246 offset:33792
    v_mfma_f32_16x16x32_bf16 v[32:35], v[124:127], v[64:67], v[32:35]
    v_mfma_f32_16x16x32_bf16 v[36:39], v[140:143], v[64:67], v[36:39]
    v_mfma_f32_16x16x32_bf16 v[40:43], v[156:159], v[64:67], v[40:43]
    v_mfma_f32_16x16x32_bf16 v[44:47], v[172:175], v[64:67], v[44:47]
    v_mfma_f32_16x16x32_bf16 v[48:51], v[188:191], v[64:67], v[48:51]
    v_mfma_f32_16x16x32_bf16 v[36:39], v[124:127], v[68:71], v[36:39]
    v_mfma_f32_16x16x32_bf16 v[40:43], v[140:143], v[68:71], v[40:43]
    v_mfma_f32_16x16x32_bf16 v[44:47], v[156:159], v[68:71], v[44:47]
    v_mfma_f32_16x16x32_bf16 v[48:51], v[172:175], v[68:71], v[48:51]
    s_waitcnt lgkmcnt(0)
    s_barrier
    v_mfma_f32_16x16x32_bf16 v[40:43], v[124:127], v[72:75], v[40:43]
    s_mov_b32 s74, s76
    s_mul_i32 s50, s74, 88064
    v_mfma_f32_16x16x32_bf16 v[44:47], v[140:143], v[72:75], v[44:47]
    s_add_u32 s50, s50, s64
    s_mul_i32 s51, s74, 3072
    v_mfma_f32_16x16x32_bf16 v[48:51], v[156:159], v[72:75], v[48:51]
    s_add_u32 s51, s51, s65
    s_add_u32 s50, s50, 704512
    v_mfma_f32_16x16x32_bf16 v[44:47], v[124:127], v[76:79], v[44:47]
    s_add_u32 m0, s51, 0
    s_nop 0
    buffer_load_dwordx4 v248, s[28:31], s50 offen offset:0 lds
    v_mfma_f32_16x16x32_bf16 v[48:51], v[140:143], v[76:79], v[48:51]
    v_mfma_f32_16x16x32_bf16 v[48:51], v[124:127], v[80:83], v[48:51]
    buffer_load_dwordx2 v[6:7], v251, s[36:39], s57 offen sc1
    v_mfma_f32_16x16x32_bf16 v[20:23], v[128:131], v[84:87], v[20:23]
    buffer_load_dwordx4 v249, s[28:31], s50 offen offset:1024 lds
    v_mfma_f32_16x16x32_bf16 v[24:27], v[128:131], v[88:91], v[24:27]
    v_mfma_f32_16x16x32_bf16 v[24:27], v[144:147], v[84:87], v[24:27]
    s_nop 4
    ds_write_b128 v4, v[20:23] offset:0
    v_mfma_f32_16x16x32_bf16 v[28:31], v[128:131], v[92:95], v[28:31]
    buffer_load_dwordx4 v250, s[28:31], s50 offen offset:2048 lds
    s_add_u32 s74, s74, 1
    v_mfma_f32_16x16x32_bf16 v[28:31], v[144:147], v[88:91], v[28:31]
    s_and_b32 s74, s74, 3
    s_mul_i32 s50, s74, 88064
    v_mfma_f32_16x16x32_bf16 v[28:31], v[160:163], v[84:87], v[28:31]
    ds_write_b128 v4, v[24:27] offset:1024
    s_add_u32 s50, s50, s64
    v_mfma_f32_16x16x32_bf16 v[32:35], v[128:131], v[96:99], v[32:35]
    s_mul_i32 s51, s74, 3072
    s_add_u32 s51, s51, s65
    v_mfma_f32_16x16x32_bf16 v[32:35], v[144:147], v[92:95], v[32:35]
    s_add_u32 s50, s50, 704512
    s_add_u32 m0, s51, 0
    v_mfma_f32_16x16x32_bf16 v[32:35], v[160:163], v[88:91], v[32:35]
    buffer_load_dwordx4 v248, s[28:31], s50 offen offset:0 lds
    v_mfma_f32_16x16x32_bf16 v[32:35], v[176:179], v[84:87], v[32:35]
    ds_write_b128 v4, v[28:31] offset:2048
    v_mfma_f32_16x16x32_bf16 v[36:39], v[128:131], v[100:103], v[36:39]
    v_mfma_f32_16x16x32_bf16 v[36:39], v[144:147], v[96:99], v[36:39]
    buffer_load_dwordx4 v249, s[28:31], s50 offen offset:1024 lds
    v_mfma_f32_16x16x32_bf16 v[36:39], v[160:163], v[92:95], v[36:39]
    v_mfma_f32_16x16x32_bf16 v[36:39], v[176:179], v[88:91], v[36:39]
    v_mfma_f32_16x16x32_bf16 v[36:39], v[192:195], v[84:87], v[36:39]
    s_nop 0
    ds_write_b128 v4, v[32:35] offset:3072
    buffer_load_dwordx4 v250, s[28:31], s50 offen offset:2048 lds
    v_mfma_f32_16x16x32_bf16 v[40:43], v[128:131], v[104:107], v[40:43]
    s_add_u32 s74, s74, 1
    s_and_b32 s74, s74, 3
    v_mfma_f32_16x16x32_bf16 v[40:43], v[144:147], v[100:103], v[40:43]
    s_mul_i32 s50, s74, 88064
    s_add_u32 s50, s50, s64
    v_mfma_f32_16x16x32_bf16 v[40:43], v[160:163], v[96:99], v[40:43]
    s_mul_i32 s51, s74, 3072
    s_add_u32 s51, s51, s65
    v_mfma_f32_16x16x32_bf16 v[40:43], v[176:179], v[92:95], v[40:43]
    s_add_u32 s50, s50, 704512
    s_add_u32 m0, s51, 0
    v_mfma_f32_16x16x32_bf16 v[40:43], v[192:195], v[88:91], v[40:43]
    buffer_load_dwordx4 v248, s[28:31], s50 offen offset:0 lds
    v_mfma_f32_16x16x32_bf16 v[40:43], v[208:211], v[84:87], v[40:43]
    ds_write_b128 v4, v[36:39] offset:4096
    v_mfma_f32_16x16x32_bf16 v[44:47], v[128:131], v[108:111], v[44:47]
    v_mfma_f32_16x16x32_bf16 v[44:47], v[144:147], v[104:107], v[44:47]
    buffer_load_dwordx4 v249, s[28:31], s50 offen offset:1024 lds
    v_mfma_f32_16x16x32_bf16 v[44:47], v[160:163], v[100:103], v[44:47]
    v_mfma_f32_16x16x32_bf16 v[44:47], v[176:179], v[96:99], v[44:47]
    v_mfma_f32_16x16x32_bf16 v[44:47], v[192:195], v[92:95], v[44:47]
    buffer_load_dwordx4 v250, s[28:31], s50 offen offset:2048 lds
    s_add_u32 s74, s74, 1
    v_mfma_f32_16x16x32_bf16 v[44:47], v[208:211], v[88:91], v[44:47]
    s_and_b32 s74, s74, 3
    s_mul_i32 s50, s74, 88064
    v_mfma_f32_16x16x32_bf16 v[44:47], v[224:227], v[84:87], v[44:47]
    ds_write_b128 v4, v[40:43] offset:5120
    s_add_u32 s50, s50, s64
    v_mfma_f32_16x16x32_bf16 v[48:51], v[128:131], v[112:115], v[48:51]
    s_mul_i32 s51, s74, 3072
    s_add_u32 s51, s51, s65
    v_mfma_f32_16x16x32_bf16 v[48:51], v[144:147], v[108:111], v[48:51]
    s_add_u32 s50, s50, 704512
    s_add_u32 m0, s51, 0
    v_mfma_f32_16x16x32_bf16 v[48:51], v[160:163], v[104:107], v[48:51]
    buffer_load_dwordx4 v248, s[28:31], s50 offen offset:0 lds
    v_mfma_f32_16x16x32_bf16 v[48:51], v[176:179], v[100:103], v[48:51]
    v_mfma_f32_16x16x32_bf16 v[48:51], v[192:195], v[96:99], v[48:51]
    v_mfma_f32_16x16x32_bf16 v[48:51], v[208:211], v[92:95], v[48:51]
    buffer_load_dwordx4 v249, s[28:31], s50 offen offset:1024 lds
    v_mfma_f32_16x16x32_bf16 v[48:51], v[224:227], v[88:91], v[48:51]
    v_mfma_f32_16x16x32_bf16 v[48:51], v[240:243], v[84:87], v[48:51]
    ds_write_b128 v4, v[44:47] offset:6144
    ds_read_b64 v[52:53], v16 offset:256
    ds_read_b64 v[54:55], v16 offset:0
    ds_read_b64 v[56:57], v16 offset:6400
    ds_read_b64 v[58:59], v16 offset:6144
    buffer_load_dwordx4 v250, s[28:31], s50 offen offset:2048 lds
    s_lshl_b32 s58, s78, 16
    s_and_b32 s59, s78, 0xffff0000
    v_mov_b32 v146, v253
    v_mov_b32 v147, v252
    ds_write_b128 v4, v[48:51] offset:7168
    s_waitcnt lgkmcnt(4)
    v_and_b32 v100, 0xffff0000, v53
    v_lshlrev_b32 v101, 16, v53
    v_and_b32 v102, 0xffff0000, v52
    v_lshlrev_b32 v103, 16, v52
    s_waitcnt lgkmcnt(3)
    v_and_b32 v104, 0xffff0000, v55
    v_lshlrev_b32 v105, 16, v55
    v_and_b32 v106, 0xffff0000, v54
    v_lshlrev_b32 v107, 16, v54
    s_waitcnt lgkmcnt(2)
    v_and_b32 v108, 0xffff0000, v57
    v_lshlrev_b32 v109, 16, v57
    v_and_b32 v110, 0xffff0000, v56
    v_lshlrev_b32 v111, 16, v56
    s_waitcnt lgkmcnt(1)
    v_and_b32 v112, 0xffff0000, v59
    v_lshlrev_b32 v113, 16, v59
    v_and_b32 v114, 0xffff0000, v58
    v_lshlrev_b32 v115, 16, v58
    s_waitcnt vmcnt(0)
    s_waitcnt lgkmcnt(0)
    s_barrier
    ds_read_b128 v[64:67], v15 offset:0
    ds_read_b128 v[68:71], v15 offset:8192
    ds_read_b128 v[72:75], v15 offset:16384
    ds_read_b128 v[76:79], v15 offset:24576
    ds_read_b128 v[80:83], v15 offset:1024
    ds_read_b128 v[84:87], v15 offset:9216
    ds_read_b128 v[88:91], v15 offset:17408
    ds_read_b128 v[92:95], v15 offset:25600
    s_waitcnt lgkmcnt(7)
    v_pk_fma_f32 v[64:65], v[100:101], s[58:59], v[64:65] op_sel:[0,0,0] op_sel_hi:[1,0,1]
    s_waitcnt lgkmcnt(6)
    v_pk_add_f32 v[64:65], v[64:65], v[68:69]
    v_pk_fma_f32 v[66:67], v[102:103], s[58:59], v[66:67] op_sel:[0,0,0] op_sel_hi:[1,0,1]
    v_pk_add_f32 v[66:67], v[66:67], v[70:71]
    s_waitcnt lgkmcnt(5)
    v_pk_fma_f32 v[72:73], v[108:109], s[58:59], v[72:73] op_sel:[0,1,0] op_sel_hi:[1,1,1]
    s_waitcnt lgkmcnt(4)
    v_pk_add_f32 v[72:73], v[72:73], v[76:77]
    v_pk_fma_f32 v[74:75], v[110:111], s[58:59], v[74:75] op_sel:[0,1,0] op_sel_hi:[1,1,1]
    v_pk_add_f32 v[74:75], v[74:75], v[78:79]
    v_cvt_pk_bf16_f32 v116, v64, v72
    v_cvt_pk_bf16_f32 v117, v65, v73
    v_cvt_pk_bf16_f32 v118, v66, v74
    v_cvt_pk_bf16_f32 v119, v67, v75
    s_lshl_b32 s56, s79, 4
    buffer_store_dwordx4 v[116:119], v17, s[12:15], s56 offen sc1
    v_cndmask_b32 v124, v116, v118, s[70:71]
    v_cndmask_b32 v125, v117, v119, s[70:71]
    s_add_u32 s56, s79, 0
    buffer_store_dwordx2 v[124:125], v18, s[12:15], s56 offen sc1
    s_waitcnt lgkmcnt(3)
    v_pk_fma_f32 v[80:81], v[104:105], s[58:59], v[80:81] op_sel:[0,0,0] op_sel_hi:[1,0,1]
    s_waitcnt lgkmcnt(2)
    v_pk_add_f32 v[80:81], v[80:81], v[84:85]
    v_pk_fma_f32 v[82:83], v[106:107], s[58:59], v[82:83] op_sel:[0,0,0] op_sel_hi:[1,0,1]
    v_pk_add_f32 v[82:83], v[82:83], v[86:87]
    s_waitcnt lgkmcnt(1)
    v_pk_fma_f32 v[88:89], v[112:113], s[58:59], v[88:89] op_sel:[0,1,0] op_sel_hi:[1,1,1]
    s_waitcnt lgkmcnt(0)
    v_pk_add_f32 v[88:89], v[88:89], v[92:93]
    v_pk_fma_f32 v[90:91], v[114:115], s[58:59], v[90:91] op_sel:[0,1,0] op_sel_hi:[1,1,1]
    v_pk_add_f32 v[90:91], v[90:91], v[94:95]
    v_cvt_pk_bf16_f32 v120, v80, v88
    v_cvt_pk_bf16_f32 v121, v81, v89
    v_cvt_pk_bf16_f32 v122, v82, v90
    v_cvt_pk_bf16_f32 v123, v83, v91
    s_lshl_b32 s56, s79, 4
    s_add_u32 s56, s56, 704512
    buffer_store_dwordx4 v[120:123], v17, s[12:15], s56 offen sc1
    v_cndmask_b32 v126, v120, v122, s[70:71]
    v_cndmask_b32 v127, v121, v123, s[70:71]
    s_add_u32 s56, s79, 16384
    buffer_store_dwordx2 v[126:127], v18, s[12:15], s56 offen sc1
    v_cmp_ne_u32 vcc, s67, v6
    s_nop 0
    s_cbranch_vccnz COLD_5
COLDE_6:
    v_cmp_ne_u32 vcc, s52, v7
    s_nop 0
    s_cmp_eq_u64 vcc, 0
    s_cselect_b32 s44, 1, 0
    ds_read_b64_tr_b16 a[80:81], v244 offset:12288
    ds_read_b64_tr_b16 a[82:83], v244 offset:36864
    ds_read_b64_tr_b16 a[144:145], v245 offset:12288
    ds_read_b64_tr_b16 a[146:147], v245 offset:36864
    ds_read_b64_tr_b16 a[208:209], v246 offset:12288
    ds_read_b64_tr_b16 a[210:211], v246 offset:36864
    ds_read_b64_tr_b16 a[84:85], v244 offset:15360
    ds_read_b64_tr_b16 a[86:87], v244 offset:39936
    ds_read_b64_tr_b16 a[148:149], v245 offset:15360
    ds_read_b64_tr_b16 a[150:151], v245 offset:39936
    ds_read_b64_tr_b16 a[212:213], v246 offset:15360
    ds_read_b64_tr_b16 a[214:215], v246 offset:39936
    ds_read_b64_tr_b16 a[88:89], v244 offset:18432
    ds_read_b64_tr_b16 a[90:91], v244 offset:43008
    ds_read_b64_tr_b16 a[152:153], v245 offset:18432
    ds_read_b64_tr_b16 a[154:155], v245 offset:43008
    ds_read_b64_tr_b16 a[216:217], v246 offset:18432
    ds_read_b64_tr_b16 a[218:219], v246 offset:43008
    ds_read_b64_tr_b16 a[92:93], v244 offset:21504
    ds_read_b64_tr_b16 a[94:95], v244 offset:46080
    ds_read_b64_tr_b16 a[156:157], v245 offset:21504
    ds_read_b64_tr_b16 a[158:159], v245 offset:46080
    ds_read_b64_tr_b16 a[220:221], v246 offset:21504
    ds_read_b64_tr_b16 a[222:223], v246 offset:46080
    ds_read_b64_tr_b16 a[96:97], v244 offset:0
    ds_read_b64_tr_b16 a[98:99], v244 offset:24576
    ds_read_b64_tr_b16 a[160:161], v245 offset:0
    ds_read_b64_tr_b16 a[162:163], v245 offset:24576
    ds_read_b64_tr_b16 a[224:225], v246 offset:0
    ds_read_b64_tr_b16 a[226:227], v246 offset:24576
    ds_read_b64_tr_b16 a[100:101], v244 offset:3072
    ds_read_b64_tr_b16 a[102:103], v244 offset:27648
    ds_read_b64_tr_b16 a[164:165], v245 offset:3072
    ds_read_b64_tr_b16 a[166:167], v245 offset:27648
    ds_read_b64_tr_b16 a[228:229], v246 offset:3072
    ds_read_b64_tr_b16 a[230:231], v246 offset:27648
    ds_read_b64_tr_b16 a[104:105], v244 offset:6144
    ds_read_b64_tr_b16 a[106:107], v244 offset:30720
    ds_read_b64_tr_b16 a[168:169], v245 offset:6144
    ds_read_b64_tr_b16 a[170:171], v245 offset:30720
    ds_read_b64_tr_b16 a[232:233], v246 offset:6144
    ds_read_b64_tr_b16 a[234:235], v246 offset:30720
    ds_read_b64_tr_b16 a[108:109], v244 offset:9216
    ds_read_b64_tr_b16 a[110:111], v244 offset:33792
    ds_read_b64_tr_b16 a[172:173], v245 offset:9216
    ds_read_b64_tr_b16 a[174:175], v245 offset:33792
    ds_read_b64_tr_b16 a[236:237], v246 offset:9216
    ds_read_b64_tr_b16 a[238:239], v246 offset:33792
    s_load_dwordx2 s[32:33], s[0:1], 64
    s_load_dwordx2 s[34:35], s[0:1], 80
    s_lshl_b32 s58, s3, 6
    s_lshl3_add_u32 s58, s4, s58
    v_lshrrev_b32 v14, 1, v1
    v_lshlrev_b32 v14, 10, v14
    v_and_b32 v15, 1, v1
    v_lshl_add_u32 v14, v15, 4, v14
    s_lshl_b32 s59, s5, 8
    s_lshl_b32 s57, s4, 5
    s_add_u32 s59, s59, s57
    v_add_u32 v4, s59, v14
    s_cmp_eq_u32 s4, 0
    s_cselect_b32 s57, 0, 0x40000000
    s_cmp_eq_u32 s4, 7
    s_cselect_b32 s57, 1, s57
    s_add_u32 s59, s57, s3
    s_sub_u32 s56, s59, 1
    s_lshl_b32 s59, s59, 12
    s_lshl_b32 s55, s5, 10
    s_add_u32 s59, s59, s55
    s_add_u32 s59, s59, 0x600000
    s_cmp_lt_u32 s56, 31
    s_cselect_b32 s59, s59, 0x40000000
    v_and_b32 v5, 15, v1
    v_lshlrev_b32 v5, 6, v5
    v_and_b32 v15, 48, v1
    v_add_u32 v5, v5, v15
    v_add_u32 v5, s59, v5
    s_lshl1_add_u32 s59, s5, s58
    s_lshl_b32 s59, s59, 10
    v_add_u32 v16, s59, v2
    s_cmp_eq_u32 s4, 0
    s_cselect_b32 s56, -2, 64
    s_add_u32 s56, s56, s5
    s_cmp_lt_u32 s5, 2
    s_cselect_b32 s55, s57, 0x40000000
    s_add_u32 s45, s56, 2
    s_lshl_b32 s45, s45, 10
    s_lshl_b32 s57, s3, 6
    s_add_u32 s57, s57, s56
    s_lshl_b32 s57, s57, 10
    s_cmp_eq_u32 s55, 0x40000000
    s_cselect_b32 s45, 0x40000000, s45
    s_cselect_b32 s57, 0x40000000, s57
    v_add_u32 v17, s57, v2
    s_lshl_b32 s59, s5, 3
    s_add_u32 s59, s59, 32768
    v_lshl_add_u32 v8, v1, 5, s59
    s_cmp_eq_u32 s4, 0
    s_cselect_b32 s59, 0, 2
    s_add_u32 s59, s59, s7
    s_lshl_b32 s59, s59, 2
    s_add_u32 s59, s59, 40960
    v_and_b32 v9, 15, v1
    v_lshl_add_u32 v9, v9, 4, s59
    v_lshrrev_b32 v15, 4, v1
    v_lshl_add_u32 v9, v15, 10, v9
    v_mov_b32 v168, 0x3f803f80
    v_mov_b32 v169, 0x3f803f80
    v_mov_b32 v170, 0x3f803f80
    v_mov_b32 v171, 0x3f803f80
    s_nop 1
    v_mfma_f32_16x16x32_bf16 v[156:159], a[64:67], v[168:171], 0
    v_mfma_f32_16x16x32_bf16 v[160:163], a[128:131], v[168:171], 0
    v_mfma_f32_16x16x32_bf16 v[164:167], a[192:195], v[168:171], 0
    v_mfma_f32_16x16x32_bf16 v[156:159], a[68:71], v[168:171], v[156:159]
    v_mfma_f32_16x16x32_bf16 v[160:163], a[132:135], v[168:171], v[160:163]
    v_mfma_f32_16x16x32_bf16 v[164:167], a[196:199], v[168:171], v[164:167]
    v_mfma_f32_16x16x32_bf16 v[156:159], a[72:75], v[168:171], v[156:159]
    v_mfma_f32_16x16x32_bf16 v[160:163], a[136:139], v[168:171], v[160:163]
    v_mfma_f32_16x16x32_bf16 v[164:167], a[200:203], v[168:171], v[164:167]
    v_mfma_f32_16x16x32_bf16 v[156:159], a[76:79], v[168:171], v[156:159]
    v_mfma_f32_16x16x32_bf16 v[160:163], a[140:143], v[168:171], v[160:163]
    v_mfma_f32_16x16x32_bf16 v[164:167], a[204:207], v[168:171], v[164:167]
    s_waitcnt lgkmcnt(0)
    v_mfma_f32_16x16x32_bf16 v[156:159], a[80:83], v[168:171], v[156:159]
    v_mfma_f32_16x16x32_bf16 v[160:163], a[144:147], v[168:171], v[160:163]
    v_mfma_f32_16x16x32_bf16 v[164:167], a[208:211], v[168:171], v[164:167]
    v_mfma_f32_16x16x32_bf16 v[156:159], a[84:87], v[168:171], v[156:159]
    v_mfma_f32_16x16x32_bf16 v[160:163], a[148:151], v[168:171], v[160:163]
    v_mfma_f32_16x16x32_bf16 v[164:167], a[212:215], v[168:171], v[164:167]
    v_mfma_f32_16x16x32_bf16 v[156:159], a[88:91], v[168:171], v[156:159]
    v_mfma_f32_16x16x32_bf16 v[160:163], a[152:155], v[168:171], v[160:163]
    v_mfma_f32_16x16x32_bf16 v[164:167], a[216:219], v[168:171], v[164:167]
    v_mfma_f32_16x16x32_bf16 v[156:159], a[92:95], v[168:171], v[156:159]
    v_mfma_f32_16x16x32_bf16 v[160:163], a[156:159], v[168:171], v[160:163]
    v_mfma_f32_16x16x32_bf16 v[164:167], a[220:223], v[168:171], v[164:167]
    s_waitcnt vmcnt(0)
    s_barrier
    s_cmp_lg_u32 s5, 0
    s_cbranch_scc1 W0_9
    s_lshl2_add_u32 s59, s77, s53
    s_add_u32 s59, s59, 0x58000
    s_mov_b64 exec, 1
    buffer_store_dword v19, off, s[36:39], s59 sc1
    buffer_store_dword v19, off, s[36:39], s59 offset:2048
    s_mov_b64 exec, -1
W0_9:
    buffer_load_dwordx4 v[20:23], v16, s[8:11], 0 offen
    buffer_load_dwordx4 v[24:27], v16, s[8:11], 0 offen offset:1024
    buffer_load_dwordx4 v[28:31], v17, s[8:11], 0 offen
    v_min_u32 v3, 7, v1
    v_lshlrev_b32 v3, 2, v3
    v_lshlrev_b32 v148, 15, v1
    s_lshl_b32 s59, s77, 10
    s_add_u32 s59, s59, 384
    v_add_u32 v148, s59, v148
    s_mov_b64 s[8:9], s[34:35]
    s_cmp_eq_u32 s5, 0
    s_cselect_b32 s10, 1409024, 0
    s_mov_b32 s11, 0x20000
    s_mov_b32 s74, s76
    s_mul_i32 s50, s74, 65536
    s_add_u32 s50, s50, s63
    s_mul_i32 s51, s74, 4096
    s_add_u32 s51, s51, s65
    s_add_u32 m0, s51, 0
    s_nop 0
    buffer_load_dwordx4 v147, s[16:19], s50 offen offset:0 lds
    s_add_u32 s50, s50, 15360
    buffer_load_dwordx4 v147, s[16:19], s50 offen offset:1024 lds
    s_add_u32 s50, s50, 15360
    buffer_load_dwordx4 v147, s[16:19], s50 offen offset:2048 lds
    s_add_u32 s50, s50, 15360
    buffer_load_dwordx4 v147, s[16:19], s50 offen offset:3072 lds
    s_add_u32 s74, s74, 1
    s_and_b32 s74, s74, 3
    s_mul_i32 s50, s74, 65536
    s_add_u32 s50, s50, s63
    s_mul_i32 s51, s74, 4096
    s_add_u32 s51, s51, s65
    s_add_u32 m0, s51, 0
    s_nop 0
    buffer_load_dwordx4 v147, s[16:19], s50 offen offset:0 lds
    s_add_u32 s50, s50, 15360
    buffer_load_dwordx4 v147, s[16:19], s50 offen offset:1024 lds
    s_waitcnt vmcnt(8)
    v_lshlrev_b32 v32, 16, v20
    v_and_b32 v33, 0xffff0000, v20
    v_lshlrev_b32 v34, 16, v21
    v_and_b32 v35, 0xffff0000, v21
    s_add_u32 s50, s50, 15360
    v_lshlrev_b32 v36, 16, v22
    v_and_b32 v37, 0xffff0000, v22
    v_lshlrev_b32 v38, 16, v23
    v_and_b32 v39, 0xffff0000, v23
    buffer_load_dwordx4 v147, s[16:19], s50 offen offset:2048 lds
    s_waitcnt vmcnt(8)
    v_lshlrev_b32 v40, 16, v24
    v_and_b32 v41, 0xffff0000, v24
    v_lshlrev_b32 v42, 16, v25
    v_and_b32 v43, 0xffff0000, v25
    s_add_u32 s50, s50, 15360
    v_lshlrev_b32 v44, 16, v26
    v_and_b32 v45, 0xffff0000, v26
    v_lshlrev_b32 v46, 16, v27
    v_and_b32 v47, 0xffff0000, v27
    s_waitcnt vmcnt(7)
    v_lshlrev_b32 v48, 16, v28
    v_and_b32 v49, 0xffff0000, v28
    v_lshlrev_b32 v50, 16, v29
    v_and_b32 v51, 0xffff0000, v29
    buffer_load_dwordx4 v147, s[16:19], s50 offen offset:3072 lds
    v_lshlrev_b32 v52, 16, v30
    v_and_b32 v53, 0xffff0000, v30
    v_lshlrev_b32 v54, 16, v31
    v_and_b32 v55, 0xffff0000, v31
    s_add_u32 s74, s74, 1
    v_pk_add_f32 v[124:125], v[32:33], v[34:35]
    v_pk_mul_f32 v[126:127], v[32:33], v[32:33]
    v_pk_add_f32 v[128:129], v[40:41], v[42:43]
    v_pk_mul_f32 v[130:131], v[40:41], v[40:41]
    s_and_b32 s74, s74, 3
    v_pk_add_f32 v[132:133], v[48:49], v[50:51]
    v_pk_mul_f32 v[134:135], v[48:49], v[48:49]
    v_pk_add_f32 v[124:125], v[124:125], v[36:37]
    v_pk_add_f32 v[128:129], v[128:129], v[44:45]
    s_mul_i32 s50, s74, 65536
    v_pk_add_f32 v[132:133], v[132:133], v[52:53]
    v_pk_add_f32 v[124:125], v[124:125], v[38:39]
    v_pk_add_f32 v[128:129], v[128:129], v[46:47]
    v_pk_add_f32 v[132:133], v[132:133], v[54:55]
    s_add_u32 s50, s50, s63
    v_pk_fma_f32 v[126:127], v[34:35], v[34:35], v[126:127]
    v_pk_fma_f32 v[130:131], v[42:43], v[42:43], v[130:131]
    v_pk_fma_f32 v[134:135], v[50:51], v[50:51], v[134:135]
    v_pk_fma_f32 v[126:127], v[36:37], v[36:37], v[126:127]
    s_mul_i32 s51, s74, 4096
    v_pk_fma_f32 v[130:131], v[44:45], v[44:45], v[130:131]
    v_pk_fma_f32 v[134:135], v[52:53], v[52:53], v[134:135]
    v_pk_fma_f32 v[126:127], v[38:39], v[38:39], v[126:127]
    v_pk_fma_f32 v[130:131], v[46:47], v[46:47], v[130:131]
    s_add_u32 s51, s51, s65
    v_pk_fma_f32 v[134:135], v[54:55], v[54:55], v[134:135]
    v_add_f32 v116, v124, v125
    v_add_f32 v120, v126, v127
    v_add_f32 v117, v128, v129
    s_add_u32 m0, s51, 0
    v_add_f32 v121, v130, v131
    v_add_f32 v118, v132, v133
    v_add_f32 v122, v134, v135
    v_mov_b32 v119, 0
    buffer_load_dwordx4 v147, s[16:19], s50 offen offset:0 lds
    v_mov_b32 v123, 0
    v_permlane32_swap_b32 v116, v118
    v_permlane32_swap_b32 v117, v119
    v_permlane32_swap_b32 v120, v122
    s_add_u32 s50, s50, 15360
    v_permlane32_swap_b32 v121, v123
    v_add_f32 v116, v116, v118
    v_add_f32 v117, v117, v119
    v_add_f32 v120, v120, v122
    v_add_f32 v121, v121, v123
    v_permlane16_swap_b32 v116, v117
    s_nop 0
    v_permlane16_swap_b32 v120, v121
    v_add_f32 v116, v116, v117
    buffer_load_dwordx4 v147, s[16:19], s50 offen offset:1024 lds
    v_add_f32 v120, v120, v121
    v_add_f32_dpp v116, v116, v116 row_ror:8 row_mask:0xf bank_mask:0xf
    s_nop 0
    v_add_f32_dpp v120, v120, v120 row_ror:8 row_mask:0xf bank_mask:0xf
    v_add_f32_dpp v116, v116, v116 row_ror:4 row_mask:0xf bank_mask:0xf
    s_add_u32 s50, s50, 15360
    v_add_f32_dpp v120, v120, v120 row_ror:4 row_mask:0xf bank_mask:0xf
    v_add_f32_dpp v116, v116, v116 row_ror:2 row_mask:0xf bank_mask:0xf
    s_nop 0
    v_add_f32_dpp v120, v120, v120 row_ror:2 row_mask:0xf bank_mask:0xf
    v_add_f32_dpp v116, v116, v116 row_ror:1 row_mask:0xf bank_mask:0xf
    s_nop 0
    v_add_f32_dpp v120, v120, v120 row_ror:1 row_mask:0xf bank_mask:0xf
    v_mul_f32 v116, s54, v116
    v_mul_f32 v117, v116, v116
    v_fma_f32 v120, v120, s54, -v117
    buffer_load_dwordx4 v147, s[16:19], s50 offen offset:2048 lds
    v_max_f32 v120, 0, v120
    v_add_f32 v120, 0x3727c5ac, v120
    v_rsq_f32 v120, v120
    s_nop 0
    v_mul_f32 v116, v116, v120
    s_add_u32 s50, s50, 15360
    buffer_load_dwordx4 v147, s[16:19], s50 offen offset:3072 lds
    s_add_u32 s74, s74, 1
    s_and_b32 s74, s74, 3
    s_mul_i32 s50, s74, 65536
    s_add_u32 s50, s50, s63
    s_mul_i32 s51, s74, 4096
    s_add_u32 s51, s51, s65
    s_add_u32 m0, s51, 0
    s_nop 0
    buffer_load_dwordx4 v147, s[16:19], s50 offen offset:0 lds
    s_add_u32 s50, s50, 15360
    buffer_load_dwordx4 v147, s[16:19], s50 offen offset:1024 lds
    s_add_u32 s50, s50, 15360
    buffer_load_dwordx4 v147, s[16:19], s50 offen offset:2048 lds
    s_add_u32 s50, s50, 15360
    buffer_load_dwordx4 v147, s[16:19], s50 offen offset:3072 lds
    buffer_load_dword v149, v148, s[8:11], 0 offen
    s_nop 0
    v_readlane_b32 s68, v120, 0
    v_readlane_b32 s69, v116, 0
    v_readlane_b32 s70, v120, 16
    v_readlane_b32 s71, v116, 16
    v_readlane_b32 s72, v120, 32
    v_readlane_b32 s73, v116, 32
    v_pk_fma_f32 v[56:57], v[32:33], s[68:69], s[68:69] op_sel:[0,0,1] op_sel_hi:[1,0,1] neg_lo:[0,0,1] neg_hi:[0,0,1]
    v_pk_fma_f32 v[58:59], v[34:35], s[68:69], s[68:69] op_sel:[0,0,1] op_sel_hi:[1,0,1] neg_lo:[0,0,1] neg_hi:[0,0,1]
    v_pk_fma_f32 v[60:61], v[36:37], s[68:69], s[68:69] op_sel:[0,0,1] op_sel_hi:[1,0,1] neg_lo:[0,0,1] neg_hi:[0,0,1]
    v_pk_fma_f32 v[62:63], v[38:39], s[68:69], s[68:69] op_sel:[0,0,1] op_sel_hi:[1,0,1] neg_lo:[0,0,1] neg_hi:[0,0,1]
    v_pk_fma_f32 v[64:65], v[40:41], s[70:71], s[70:71] op_sel:[0,0,1] op_sel_hi:[1,0,1] neg_lo:[0,0,1] neg_hi:[0,0,1]
    v_pk_fma_f32 v[66:67], v[42:43], s[70:71], s[70:71] op_sel:[0,0,1] op_sel_hi:[1,0,1] neg_lo:[0,0,1] neg_hi:[0,0,1]
    v_pk_fma_f32 v[68:69], v[44:45], s[70:71], s[70:71] op_sel:[0,0,1] op_sel_hi:[1,0,1] neg_lo:[0,0,1] neg_hi:[0,0,1]
    v_pk_fma_f32 v[70:71], v[46:47], s[70:71], s[70:71] op_sel:[0,0,1] op_sel_hi:[1,0,1] neg_lo:[0,0,1] neg_hi:[0,0,1]
    v_pk_fma_f32 v[72:73], v[48:49], s[72:73], s[72:73] op_sel:[0,0,1] op_sel_hi:[1,0,1] neg_lo:[0,0,1] neg_hi:[0,0,1]
    v_pk_fma_f32 v[74:75], v[50:51], s[72:73], s[72:73] op_sel:[0,0,1] op_sel_hi:[1,0,1] neg_lo:[0,0,1] neg_hi:[0,0,1]
    v_pk_fma_f32 v[76:77], v[52:53], s[72:73], s[72:73] op_sel:[0,0,1] op_sel_hi:[1,0,1] neg_lo:[0,0,1] neg_hi:[0,0,1]
    v_pk_fma_f32 v[78:79], v[54:55], s[72:73], s[72:73] op_sel:[0,0,1] op_sel_hi:[1,0,1] neg_lo:[0,0,1] neg_hi:[0,0,1]
    s_waitcnt vmcnt(1)
    ds_read_b64_tr_b16 a[0:1], v146 offset:0
    ds_read_b64_tr_b16 a[2:3], v146 offset:256
    ds_read_b64_tr_b16 a[4:5], v146 offset:1024
    ds_read_b64_tr_b16 a[6:7], v146 offset:1280
    ds_read_b64_tr_b16 a[8:9], v146 offset:2048
    ds_read_b64_tr_b16 a[10:11], v146 offset:2304
    ds_read_b64_tr_b16 a[12:13], v146 offset:3072
    ds_read_b64_tr_b16 a[14:15], v146 offset:3328
    ds_read_b64_tr_b16 a[16:17], v146 offset:4096
    ds_read_b64_tr_b16 a[18:19], v146 offset:4352
    ds_read_b64_tr_b16 a[20:21], v146 offset:5120
    ds_read_b64_tr_b16 a[22:23], v146 offset:5376
    ds_read_b64_tr_b16 a[24:25], v146 offset:6144
    ds_read_b64_tr_b16 a[26:27], v146 offset:6400
    ds_read_b64_tr_b16 a[28:29], v146 offset:7168
    ds_read_b64_tr_b16 a[30:31], v146 offset:7424
    ds_read_b64_tr_b16 a[32:33], v146 offset:8192
    ds_read_b64_tr_b16 a[34:35], v146 offset:8448
    ds_read_b64_tr_b16 a[36:37], v146 offset:9216
    ds_read_b64_tr_b16 a[38:39], v146 offset:9472
    ds_read_b64_tr_b16 a[40:41], v146 offset:10240
    ds_read_b64_tr_b16 a[42:43], v146 offset:10496
    ds_read_b64_tr_b16 a[44:45], v146 offset:11264
    ds_read_b64_tr_b16 a[46:47], v146 offset:11520
    ds_read_b64_tr_b16 a[48:49], v146 offset:12288
    ds_read_b64_tr_b16 a[50:51], v146 offset:12544
    ds_read_b64_tr_b16 a[52:53], v146 offset:13312
    ds_read_b64_tr_b16 a[54:55], v146 offset:13568
    ds_read_b64_tr_b16 a[56:57], v146 offset:14336
    ds_read_b64_tr_b16 a[58:59], v146 offset:14592
    ds_read_b64_tr_b16 a[60:61], v146 offset:15360
    ds_read_b64_tr_b16 a[62:63], v146 offset:15616
    s_cmp_lg_u32 s5, 0
    s_cbranch_scc1 W0_10
    s_cmp_eq_u32 s44, 1
    s_cbranch_scc0 LPE_14
    s_add_u32 s59, s53, 0x58800
    v_min_u32 v81, 31, v1
    v_lshlrev_b32 v81, 2, v81
    s_mov_b32 s49, 0
LP_13:
    buffer_load_dword v80, v81, s[36:39], s59 offen sc1
    s_add_u32 s49, s49, 1
    s_cmp_gt_u32 s49, 0x1000
    s_cbranch_scc1 LPE_14
    s_waitcnt vmcnt(0)
    v_cmp_ne_u32 vcc, s67, v80
    s_nop 0
    s_cbranch_vccnz LP_13
LPE_14:
    s_waitcnt vmcnt(0)
    s_mov_b32 s59, 0x58000
    s_mov_b32 s49, 0
FP_11:
    buffer_load_dwordx4 v[80:83], v2, s[36:39], s59 offen sc1
    s_add_u32 s49, s49, 1
    s_cmp_gt_u32 s49, 0x200000
    s_cbranch_scc1 FPE_12
    s_waitcnt vmcnt(0)
    v_xor_b32 v80, s67, v80
    v_xor_b32 v81, s67, v81
    v_xor_b32 v82, s67, v82
    v_xor_b32 v83, s67, v83
    v_or3_b32 v80, v80, v81, v82
    v_or_b32 v80, v80, v83
    v_cmp_ne_u32 vcc, 0, v80
    s_nop 0
    s_cbranch_vccnz FP_11
FPE_12:
    s_waitcnt vmcnt(0)
    s_cmp_lg_u32 s2, 0
    s_cbranch_scc1 W0_10
    s_mov_b32 s59, 0x59800
    s_mov_b64 exec, 1
    buffer_store_dword v19, off, s[36:39], s59 sc1
    s_mov_b64 exec, -1
W0_10:
    s_barrier
    s_lshl_b32 s59, s5, 11
    s_add_u32 m0, s59, 32768
    s_mov_b32 s58, 0x8000-1024
    buffer_load_dwordx4 v4, s[24:27], 0 offen sc1 lds
    buffer_load_dwordx4 v4, s[24:27], s58 offen offset:1024 sc1 lds
    s_lshl_b32 s59, s5, 10
    s_add_u32 m0, s59, 40960
    s_nop 0
    buffer_load_dwordx4 v5, s[12:15], 0 offen sc1 lds
    s_mov_b64 s[16:17], s[32:33]
    s_waitcnt lgkmcnt(0)
    s_mov_b32 s74, s76
    s_mul_i32 s50, s74, 65536
    s_add_u32 s50, s50, s63
    s_mul_i32 s51, s74, 4096
    s_add_u32 s51, s51, s65
    s_add_u32 m0, s51, 0
    s_nop 0
    buffer_load_dwordx4 v247, s[16:19], s50 offen offset:0 lds
    s_add_u32 s50, s50, 7168
    buffer_load_dwordx4 v247, s[16:19], s50 offen offset:1024 lds
    s_add_u32 s50, s50, 23552
    buffer_load_dwordx4 v247, s[16:19], s50 offen offset:2048 lds
    s_add_u32 s50, s50, 7168
    buffer_load_dwordx4 v247, s[16:19], s50 offen offset:3072 lds
    s_add_u32 s74, s74, 1
    s_and_b32 s74, s74, 3
    s_mul_i32 s50, s74, 65536
    s_add_u32 s50, s50, s63
    s_mul_i32 s51, s74, 4096
    s_add_u32 s51, s51, s65
    s_add_u32 m0, s51, 0
    s_nop 0
    buffer_load_dwordx4 v247, s[16:19], s50 offen offset:0 lds
    s_add_u32 s50, s50, 7168
    buffer_load_dwordx4 v247, s[16:19], s50 offen offset:1024 lds
    s_add_u32 s50, s50, 23552
    buffer_load_dwordx4 v247, s[16:19], s50 offen offset:2048 lds
    s_add_u32 s50, s50, 7168
    buffer_load_dwordx4 v247, s[16:19], s50 offen offset:3072 lds
    s_lshr_b32 s59, s4, 1
    s_lshl_b32 s59, s59, 2
    s_lshr_b32 s59, 0x4031, s59
    s_and_b32 s59, s59, 15
    s_lshl_b32 s58, s7, 5
    s_add_u32 s59, s59, s58
    s_lshl_b32 s59, s59, 10
    s_lshl_b32 s58, s6, 9
    s_add_u32 s59, s59, s58
    v_lshrrev_b32 v14, 3, v1
    v_lshlrev_b32 v14, 10, v14
    v_add_u32 v14, s59, v14
    v_and_b32 v15, 7, v1
    v_lshrrev_b32 v16, 4, v1
    v_xor_b32 v15, v15, v16
    v_lshl_add_u32 v6, v15, 4, v14
    v_xor_b32 v7, 64, v6
    s_add_u32 s58, s65, 16384
    v_add_u32 v12, s58, v2
    s_xor_b32 s58, s5, 2
    s_mul_i32 s58, s58, 24576
    s_add_u32 s58, s58, 81920
    v_add_u32 v13, s58, v2
    v_and_b32 v14, 31, v1
    v_lshrrev_b32 v15, 5, v1
    v_lshlrev_b32 v15, 5, v15
    v_lshl_add_u32 v15, v14, 10, v15
    s_lshl_b32 s58, s6, 15
    s_lshl_b32 s57, s4, 7
    s_add_u32 s58, s58, s57
    s_lshl_b32 s57, s7, 6
    s_add_u32 s58, s58, s57
    v_add_u32 v18, s58, v15
    s_lshl_b32 s59, s4, 3
    s_lshl1_add_u32 s59, s5, s59
    s_lshl_b32 s57, s59, 4
    s_lshl_b32 s56, s3, 10
    s_add_u32 s57, s57, s56
    s_add_u32 s59, s59, 2
    s_lshl_b32 s59, s59, 10
    v_and_b32 v16, 47, v1
    v_cmp_eq_u32 vcc, 0, v16
    v_mov_b32 v17, 0x40000000
    s_nop 0
    v_cndmask_b32 v16, v17, v1, vcc
    v_cmp_eq_u32 vcc, 0, v1
    s_nop 1
    v_cndmask_b32 v0, v17, v1, vcc
    v_min_u32 v3, 31, v1
    v_lshlrev_b32 v3, 2, v3
    s_lshl2_add_u32 s58, s4, s5
    s_lshl2_add_u32 s58, s58, s66
    s_cmp_eq_u32 s44, 1
    s_cselect_b32 s78, s58, 0x40000000
    s_cselect_b32 s79, 0x40000000, s58
    s_waitcnt vmcnt(8)
    s_barrier
    ds_read_b64 v[80:81], v8 offset:0
    ds_read_b64 v[82:83], v8 offset:2048
    ds_read_b64 v[84:85], v8 offset:4096
    ds_read_b64 v[86:87], v8 offset:6144
    ds_read_b32 v88, v9 offset:0
    ds_read_b32 v89, v9 offset:256
    ds_read_b32 v90, v9 offset:512
    ds_read_b32 v91, v9 offset:768
    s_waitcnt lgkmcnt(7)
    v_lshlrev_b32 v92, 16, v80
    v_and_b32 v93, 0xffff0000, v80
    s_waitcnt lgkmcnt(6)
    v_lshlrev_b32 v94, 16, v82
    v_and_b32 v95, 0xffff0000, v82
    s_add_u32 s74, s74, 1
    s_waitcnt lgkmcnt(5)
    v_lshlrev_b32 v96, 16, v84
    v_and_b32 v97, 0xffff0000, v84
    s_waitcnt lgkmcnt(4)
    v_lshlrev_b32 v98, 16, v86
    v_and_b32 v99, 0xffff0000, v86
    s_and_b32 s74, s74, 3
    v_lshlrev_b32 v100, 16, v81
    v_and_b32 v101, 0xffff0000, v81
    v_lshlrev_b32 v102, 16, v83
    v_and_b32 v103, 0xffff0000, v83
    s_mul_i32 s50, s74, 65536
    v_lshlrev_b32 v104, 16, v85
    v_and_b32 v105, 0xffff0000, v85
    v_lshlrev_b32 v106, 16, v87
    v_and_b32 v107, 0xffff0000, v87
    s_add_u32 s50, s50, s63
    s_waitcnt lgkmcnt(3)
    v_lshlrev_b32 v108, 16, v88
    v_and_b32 v109, 0xffff0000, v88
    s_waitcnt lgkmcnt(2)
    v_lshlrev_b32 v110, 16, v89
    v_and_b32 v111, 0xffff0000, v89
    s_mul_i32 s51, s74, 4096
    s_waitcnt lgkmcnt(1)
    v_lshlrev_b32 v112, 16, v90
    v_and_b32 v113, 0xffff0000, v90
    s_waitcnt lgkmcnt(0)
    v_lshlrev_b32 v114, 16, v91
    v_and_b32 v115, 0xffff0000, v91
    s_add_u32 s51, s51, s65
    v_pk_fma_f32 v[32:33], v[56:57], v[92:93], v[32:33]
    v_pk_fma_f32 v[34:35], v[58:59], v[94:95], v[34:35]
    v_pk_fma_f32 v[36:37], v[60:61], v[96:97], v[36:37]
    v_pk_fma_f32 v[38:39], v[62:63], v[98:99], v[38:39]
    s_add_u32 m0, s51, 0
    v_pk_fma_f32 v[40:41], v[64:65], v[100:101], v[40:41]
    v_pk_fma_f32 v[42:43], v[66:67], v[102:103], v[42:43]
    v_pk_fma_f32 v[44:45], v[68:69], v[104:105], v[44:45]
    v_pk_fma_f32 v[46:47], v[70:71], v[106:107], v[46:47]
    buffer_load_dwordx4 v247, s[16:19], s50 offen offset:0 lds
    v_pk_fma_f32 v[48:49], v[72:73], v[108:109], v[48:49]
    v_pk_fma_f32 v[50:51], v[74:75], v[110:111], v[50:51]
    v_pk_fma_f32 v[52:53], v[76:77], v[112:113], v[52:53]
    v_pk_fma_f32 v[54:55], v[78:79], v[114:115], v[54:55]
    s_add_u32 s50, s50, 7168
    s_nop 0
    v_pk_add_f32 v[124:125], v[32:33], v[34:35]
    v_pk_mul_f32 v[126:127], v[32:33], v[32:33]
    v_pk_add_f32 v[128:129], v[40:41], v[42:43]
    v_pk_mul_f32 v[130:131], v[40:41], v[40:41]
    v_pk_add_f32 v[132:133], v[48:49], v[50:51]
    v_pk_mul_f32 v[134:135], v[48:49], v[48:49]
    v_pk_add_f32 v[124:125], v[124:125], v[36:37]
    v_pk_add_f32 v[128:129], v[128:129], v[44:45]
    buffer_load_dwordx4 v247, s[16:19], s50 offen offset:1024 lds
    v_pk_add_f32 v[132:133], v[132:133], v[52:53]
    v_pk_add_f32 v[124:125], v[124:125], v[38:39]
    v_pk_add_f32 v[128:129], v[128:129], v[46:47]
    v_pk_add_f32 v[132:133], v[132:133], v[54:55]
    s_add_u32 s50, s50, 23552
    v_pk_fma_f32 v[126:127], v[34:35], v[34:35], v[126:127]
    v_pk_fma_f32 v[130:131], v[42:43], v[42:43], v[130:131]
    v_pk_fma_f32 v[134:135], v[50:51], v[50:51], v[134:135]
    v_pk_fma_f32 v[126:127], v[36:37], v[36:37], v[126:127]
    v_pk_fma_f32 v[130:131], v[44:45], v[44:45], v[130:131]
    v_pk_fma_f32 v[134:135], v[52:53], v[52:53], v[134:135]
    v_pk_fma_f32 v[126:127], v[38:39], v[38:39], v[126:127]
    v_pk_fma_f32 v[130:131], v[46:47], v[46:47], v[130:131]
    buffer_load_dwordx4 v247, s[16:19], s50 offen offset:2048 lds
    v_pk_fma_f32 v[134:135], v[54:55], v[54:55], v[134:135]
    v_add_f32 v116, v124, v125
    v_add_f32 v120, v126, v127
    v_add_f32 v117, v128, v129
    s_add_u32 s50, s50, 7168
    v_add_f32 v121, v130, v131
    v_add_f32 v118, v132, v133
    v_add_f32 v122, v134, v135
    v_mov_b32 v119, 0
    v_mov_b32 v123, 0
    v_permlane32_swap_b32 v116, v118
    v_permlane32_swap_b32 v117, v119
    v_permlane32_swap_b32 v120, v122
    buffer_load_dwordx4 v247, s[16:19], s50 offen offset:3072 lds
    v_permlane32_swap_b32 v121, v123
    v_add_f32 v116, v116, v118
    v_add_f32 v117, v117, v119
    v_add_f32 v120, v120, v122
    s_add_u32 s74, s74, 1
    v_add_f32 v121, v121, v123
    v_permlane16_swap_b32 v116, v117
    s_nop 0
    v_permlane16_swap_b32 v120, v121
    v_add_f32 v116, v116, v117
    s_and_b32 s74, s74, 3
    v_add_f32 v120, v120, v121
    v_add_f32_dpp v116, v116, v116 row_ror:8 row_mask:0xf bank_mask:0xf
    s_nop 0
    v_add_f32_dpp v120, v120, v120 row_ror:8 row_mask:0xf bank_mask:0xf
    v_add_f32_dpp v116, v116, v116 row_ror:4 row_mask:0xf bank_mask:0xf
    s_mul_i32 s50, s74, 65536
    v_add_f32_dpp v120, v120, v120 row_ror:4 row_mask:0xf bank_mask:0xf
    v_add_f32_dpp v116, v116, v116 row_ror:2 row_mask:0xf bank_mask:0xf
    s_nop 0
    v_add_f32_dpp v120, v120, v120 row_ror:2 row_mask:0xf bank_mask:0xf
    v_add_f32_dpp v116, v116, v116 row_ror:1 row_mask:0xf bank_mask:0xf
    s_add_u32 s50, s50, s63
    v_add_f32_dpp v120, v120, v120 row_ror:1 row_mask:0xf bank_mask:0xf
    v_mul_f32 v116, s54, v116
    v_mul_f32 v117, v116, v116
    v_fma_f32 v120, v120, s54, -v117
    s_mul_i32 s51, s74, 4096
    v_max_f32 v120, 0, v120
    v_add_f32 v140, 0x3727c5ac, v120
    v_rsq_f32 v141, v140
    v_mov_b32 v136, v116
    s_add_u32 s51, s51, s65
    v_mul_f32 v137, v140, v141
    v_mul_f32 v142, v141, v141
    v_fmaak_f32 v142, v142, v120, 0x3727c5ac
    v_rsq_f32 v143, v142
    s_add_u32 m0, s51, 0
    v_mov_b32 v139, 0
    v_mul_f32 v138, v142, v143
    v_mul_f32 v141, v141, v143
    v_mul_f32 v140, v141, v116
    buffer_load_dwordx4 v247, s[16:19], s50 offen offset:0 lds
    v_readlane_b32 s68, v141, 0
    v_readlane_b32 s69, v140, 0
    v_readlane_b32 s70, v141, 16
    v_readlane_b32 s71, v140, 16
    s_add_u32 s50, s50, 7168
    v_readlane_b32 s72, v141, 32
    v_readlane_b32 s73, v140, 32
    v_pk_fma_f32 v[56:57], v[32:33], s[68:69], s[68:69] op_sel:[0,0,1] op_sel_hi:[1,0,1] neg_lo:[0,0,1] neg_hi:[0,0,1]
    v_pk_fma_f32 v[58:59], v[34:35], s[68:69], s[68:69] op_sel:[0,0,1] op_sel_hi:[1,0,1] neg_lo:[0,0,1] neg_hi:[0,0,1]
    v_pk_fma_f32 v[60:61], v[36:37], s[68:69], s[68:69] op_sel:[0,0,1] op_sel_hi:[1,0,1] neg_lo:[0,0,1] neg_hi:[0,0,1]
    v_pk_fma_f32 v[62:63], v[38:39], s[68:69], s[68:69] op_sel:[0,0,1] op_sel_hi:[1,0,1] neg_lo:[0,0,1] neg_hi:[0,0,1]
    v_pk_fma_f32 v[64:65], v[40:41], s[70:71], s[70:71] op_sel:[0,0,1] op_sel_hi:[1,0,1] neg_lo:[0,0,1] neg_hi:[0,0,1]
    v_pk_fma_f32 v[66:67], v[42:43], s[70:71], s[70:71] op_sel:[0,0,1] op_sel_hi:[1,0,1] neg_lo:[0,0,1] neg_hi:[0,0,1]
    buffer_load_dwordx4 v247, s[16:19], s50 offen offset:1024 lds
    v_pk_fma_f32 v[68:69], v[44:45], s[70:71], s[70:71] op_sel:[0,0,1] op_sel_hi:[1,0,1] neg_lo:[0,0,1] neg_hi:[0,0,1]
    v_pk_fma_f32 v[70:71], v[46:47], s[70:71], s[70:71] op_sel:[0,0,1] op_sel_hi:[1,0,1] neg_lo:[0,0,1] neg_hi:[0,0,1]
    v_pk_fma_f32 v[72:73], v[48:49], s[72:73], s[72:73] op_sel:[0,0,1] op_sel_hi:[1,0,1] neg_lo:[0,0,1] neg_hi:[0,0,1]
    v_pk_fma_f32 v[74:75], v[50:51], s[72:73], s[72:73] op_sel:[0,0,1] op_sel_hi:[1,0,1] neg_lo:[0,0,1] neg_hi:[0,0,1]
    s_add_u32 s50, s50, 23552
    v_pk_fma_f32 v[76:77], v[52:53], s[72:73], s[72:73] op_sel:[0,0,1] op_sel_hi:[1,0,1] neg_lo:[0,0,1] neg_hi:[0,0,1]
    v_pk_fma_f32 v[78:79], v[54:55], s[72:73], s[72:73] op_sel:[0,0,1] op_sel_hi:[1,0,1] neg_lo:[0,0,1] neg_hi:[0,0,1]
    v_cvt_pk_bf16_f32 v20, v56, v57
    v_cvt_pk_bf16_f32 v21, v58, v59
    v_cvt_pk_bf16_f32 v22, v60, v61
    v_cvt_pk_bf16_f32 v23, v62, v63
    v_cvt_pk_bf16_f32 v24, v64, v65
    v_cvt_pk_bf16_f32 v25, v66, v67
    buffer_load_dwordx4 v247, s[16:19], s50 offen offset:2048 lds
    v_cvt_pk_bf16_f32 v26, v68, v69
    v_cvt_pk_bf16_f32 v27, v70, v71
    v_cvt_pk_bf16_f32 v28, v72, v73
    v_cvt_pk_bf16_f32 v29, v74, v75
    s_add_u32 s50, s50, 7168
    v_cvt_pk_bf16_f32 v30, v76, v77
    v_cvt_pk_bf16_f32 v31, v78, v79
    buffer_load_dwordx4 v247, s[16:19], s50 offen offset:3072 lds
    s_cmp_eq_u32 s44, 1
    s_cbranch_scc0 ALT_15
    buffer_store_dwordx4 v[20:23], v2, s[20:23], s59 offen
    buffer_store_dwordx4 v[24:27], v2, s[20:23], s59 offen offset:1024
    buffer_store_dwordx4 v[28:31], v2, s[20:23], s45 offen
    buffer_store_dwordx4 v[136:139], v16, s[36:39], s57 offen
ALTE_16:
    v_and_b32 v14, 31, v1
    v_lshrrev_b32 v15, 5, v1
    v_bfe_u32 v16, v1, 1, 3
    v_xor_b32 v15, v15, v16
    v_lshlrev_b32 v15, 4, v15
    v_lshl_add_u32 v15, v14, 7, v15
    s_mul_i32 s58, s6, 12288
    v_add_u32 v8, s58, v15
    v_xor_b32 v9, 32, v8
    v_xor_b32 v10, 64, v8
    v_xor_b32 v11, 96, v8
    v_xor_b32 v4, 4096, v8
    v_xor_b32 v5, 4096, v9
    v_xor_b32 v16, 4096, v10
    v_xor_b32 v17, 4096, v11
    v_lshlrev_b32 v15, 4, v14
    s_waitcnt vmcnt(0)
    buffer_store_dword v19, v0, s[36:39], s78 offen offset:0
    buffer_store_dword v19, v0, s[36:39], s79 offen offset:0 sc1
    v_mov_b32 v100, v248
    v_mov_b32 v101, v249
    v_mov_b32 v102, v250
    v_mov_b32 v128, v244
    v_mov_b32 v129, v245
    v_mov_b32 v130, v246
    v_mov_b32 v132, v156
    v_mov_b32 v133, v157
    v_mov_b32 v134, v158
    v_mov_b32 v135, v159
    v_mov_b32 v136, v160
    v_mov_b32 v137, v161
    v_mov_b32 v138, v162
    v_mov_b32 v139, v163
    v_mov_b32 v140, v164
    v_mov_b32 v141, v165
    v_mov_b32 v142, v166
    v_mov_b32 v143, v167
    v_mov_b32 v145, v247
    ds_read_b64_tr_b16 v[192:193], v146 offset:0
    ds_read_b64_tr_b16 v[194:195], v146 offset:256
    ds_read_b64_tr_b16 v[196:197], v146 offset:1024
    ds_read_b64_tr_b16 v[198:199], v146 offset:1280
    ds_read_b64_tr_b16 v[200:201], v146 offset:2048
    ds_read_b64_tr_b16 v[202:203], v146 offset:2304
    ds_read_b64_tr_b16 v[204:205], v146 offset:3072
    ds_read_b64_tr_b16 v[206:207], v146 offset:3328
    ds_read_b64_tr_b16 v[208:209], v146 offset:4096
    ds_read_b64_tr_b16 v[210:211], v146 offset:4352
    ds_read_b64_tr_b16 v[212:213], v146 offset:5120
    ds_read_b64_tr_b16 v[214:215], v146 offset:5376
    ds_read_b64_tr_b16 v[216:217], v146 offset:6144
    ds_read_b64_tr_b16 v[218:219], v146 offset:6400
    ds_read_b64_tr_b16 v[220:221], v146 offset:7168
    ds_read_b64_tr_b16 v[222:223], v146 offset:7424
    ds_read_b64_tr_b16 v[224:225], v146 offset:8192
    ds_read_b64_tr_b16 v[226:227], v146 offset:8448
    ds_read_b64_tr_b16 v[228:229], v146 offset:9216
    ds_read_b64_tr_b16 v[230:231], v146 offset:9472
    ds_read_b64_tr_b16 v[232:233], v146 offset:10240
    ds_read_b64_tr_b16 v[234:235], v146 offset:10496
    ds_read_b64_tr_b16 v[236:237], v146 offset:11264
    ds_read_b64_tr_b16 v[238:239], v146 offset:11520
    ds_read_b64_tr_b16 v[240:241], v146 offset:12288
    ds_read_b64_tr_b16 v[242:243], v146 offset:12544
    ds_read_b64_tr_b16 v[244:245], v146 offset:13312
    ds_read_b64_tr_b16 v[246:247], v146 offset:13568
    ds_read_b64_tr_b16 v[248:249], v146 offset:14336
    ds_read_b64_tr_b16 v[250:251], v146 offset:14592
    ds_read_b64_tr_b16 v[252:253], v146 offset:15360
    ds_read_b64_tr_b16 v[254:255], v146 offset:15616
    s_mov_b32 s49, 0
POLL_17:
    buffer_load_dword v14, v3, s[36:39], s66 offen offset:0 sc1
    s_add_u32 s49, s49, 1
    s_cmp_gt_u32 s49, 0x200000
    s_cbranch_scc1 POLLE_18
    s_waitcnt vmcnt(0)
    v_cmp_ne_u32 vcc, s67, v14
    s_nop 0
    s_cbranch_vccnz POLL_17
POLLE_18:
    s_waitcnt vmcnt(0)
    s_lshl_b32 s58, s5, 12
    s_lshl_b32 s53, s3, 10
    s_lshl_b32 s56, s6, 9
    s_add_u32 s53, s53, s56
    s_getpc_b64 s[12:13]
KS_PC1:
    s_mov_b32 s14, KS_END-KS_PC1
    s_mov_b32 s15, 0x20000
    s_cmp_eq_u32 s5, 1
    s_cselect_b32 s14, s14, 0
    v_lshlrev_b32 v104, 12, v1
    s_lshl_b32 s59, s77, 7
    v_add_u32 v104, s59, v104
    s_add_u32 m0, s58, 0
    s_movk_i32 s56, 0
    buffer_load_dwordx4 v6, s[20:23], s56 offen offset:0 sc1 lds
    s_movk_i32 s56, 7168
    buffer_load_dwordx4 v7, s[20:23], s56 offen offset:1024 sc1 lds
    s_movk_i32 s56, 14336
    buffer_load_dwordx4 v6, s[20:23], s56 offen offset:2048 sc1 lds
    s_movk_i32 s56, 21504
    buffer_load_dwordx4 v7, s[20:23], s56 offen offset:3072 sc1 lds
    s_add_u32 m0, s58, 16384
    s_movk_i32 s56, 128
    buffer_load_dwordx4 v6, s[20:23], s56 offen offset:0 sc1 lds
    s_movk_i32 s56, 7296
    buffer_load_dwordx4 v7, s[20:23], s56 offen offset:1024 sc1 lds
    s_movk_i32 s56, 14464
    buffer_load_dwordx4 v6, s[20:23], s56 offen offset:2048 sc1 lds
    s_movk_i32 s56, 21632
    buffer_load_dwordx4 v7, s[20:23], s56 offen offset:3072 sc1 lds
    s_add_u32 m0, s58, 32768
    s_movk_i32 s56, 256
    buffer_load_dwordx4 v6, s[20:23], s56 offen offset:0 sc1 lds
    s_movk_i32 s56, 7424
    buffer_load_dwordx4 v7, s[20:23], s56 offen offset:1024 sc1 lds
    s_movk_i32 s56, 14592
    buffer_load_dwordx4 v6, s[20:23], s56 offen offset:2048 sc1 lds
    s_movk_i32 s56, 21760
    buffer_load_dwordx4 v7, s[20:23], s56 offen offset:3072 sc1 lds
    s_waitcnt vmcnt(8)
    s_waitcnt lgkmcnt(0)
    s_barrier
    ds_read_b128 v[72:75], v4 offset:0
    ds_read_b128 v[68:71], v8 offset:0
    ds_read_b128 v[80:83], v5 offset:0
    ds_read_b128 v[76:79], v9 offset:0
    ds_read_b128 v[88:91], v16 offset:0
    ds_read_b128 v[84:87], v10 offset:0
    s_waitcnt lgkmcnt(5)
    v_mfma_f32_32x32x16_bf16 v[36:51], a[0:3], v[72:75], 0
    ds_read_b128 v[96:99], v17 offset:0
    ds_read_b128 v[92:95], v11 offset:0
    s_add_u32 m0, s58, 49152
    s_movk_i32 s56, 384
    buffer_load_dwordx4 v6, s[20:23], s56 offen offset:0 sc1 lds
    s_movk_i32 s56, 7552
    s_waitcnt lgkmcnt(6)
    v_mfma_f32_32x32x16_bf16 v[20:35], a[0:3], v[68:71], 0
    s_waitcnt lgkmcnt(5)
    v_mfma_f32_32x32x16_bf16 v[36:51], a[4:7], v[80:83], v[36:51]
    buffer_load_dwordx4 v7, s[20:23], s56 offen offset:1024 sc1 lds
    s_movk_i32 s56, 14720
    s_waitcnt lgkmcnt(4)
    v_mfma_f32_32x32x16_bf16 v[20:35], a[4:7], v[76:79], v[20:35]
    s_waitcnt lgkmcnt(3)
    v_mfma_f32_32x32x16_bf16 v[36:51], a[8:11], v[88:91], v[36:51]
    buffer_load_dwordx4 v6, s[20:23], s56 offen offset:2048 sc1 lds
    s_movk_i32 s56, 21888
    s_waitcnt lgkmcnt(2)
    v_mfma_f32_32x32x16_bf16 v[20:35], a[8:11], v[84:87], v[20:35]
    s_waitcnt vmcnt(7)
    s_barrier
    s_waitcnt lgkmcnt(1)
    v_mfma_f32_32x32x16_bf16 v[36:51], a[12:15], v[96:99], v[36:51]
    ds_read_b128 v[72:75], v4 offset:16384
    ds_read_b128 v[68:71], v8 offset:16384
    buffer_load_dwordx4 v7, s[20:23], s56 offen offset:3072 sc1 lds
    s_waitcnt lgkmcnt(2)
    v_mfma_f32_32x32x16_bf16 v[20:35], a[12:15], v[92:95], v[20:35]
    ds_read_b128 v[80:83], v5 offset:16384
    ds_read_b128 v[76:79], v9 offset:16384
    s_waitcnt lgkmcnt(3)
    v_mfma_f32_32x32x16_bf16 v[36:51], a[16:19], v[72:75], v[36:51]
    ds_read_b128 v[88:91], v16 offset:16384
    ds_read_b128 v[84:87], v10 offset:16384
    buffer_load_dwordx4 v[116:119], v18, s[20:23], 0 offen offset:2048 sc1
    s_waitcnt lgkmcnt(4)
    v_mfma_f32_32x32x16_bf16 v[20:35], a[16:19], v[68:71], v[20:35]
    ds_read_b128 v[96:99], v17 offset:16384
    ds_read_b128 v[92:95], v11 offset:16384
    s_waitcnt lgkmcnt(5)
    v_mfma_f32_32x32x16_bf16 v[36:51], a[20:23], v[80:83], v[36:51]
    buffer_load_dwordx4 v[120:123], v18, s[20:23], 0 offen offset:2064 sc1
    s_waitcnt lgkmcnt(4)
    v_mfma_f32_32x32x16_bf16 v[20:35], a[20:23], v[76:79], v[20:35]
    s_waitcnt lgkmcnt(3)
    v_mfma_f32_32x32x16_bf16 v[36:51], a[24:27], v[88:91], v[36:51]
    buffer_load_dwordx4 v[124:127], v15, s[36:39], s53 offen sc1
    s_waitcnt lgkmcnt(2)
    v_mfma_f32_32x32x16_bf16 v[20:35], a[24:27], v[84:87], v[20:35]
    s_waitcnt vmcnt(7)
    s_barrier
    s_waitcnt lgkmcnt(1)
    v_mfma_f32_32x32x16_bf16 v[36:51], a[28:31], v[96:99], v[36:51]
    ds_read_b128 v[72:75], v4 offset:32768
    ds_read_b128 v[68:71], v8 offset:32768
    buffer_load_dword v105, v104, s[12:15], 0 offen
    s_mov_b32 s74, s76
    s_mul_i32 s50, s74, 88064
    s_add_u32 s50, s50, s64
    s_waitcnt lgkmcnt(2)
    v_mfma_f32_32x32x16_bf16 v[20:35], a[28:31], v[92:95], v[20:35]
    ds_read_b128 v[80:83], v5 offset:32768
    ds_read_b128 v[76:79], v9 offset:32768
    s_mul_i32 s51, s74, 3072
    s_add_u32 s51, s51, s65
    s_add_u32 s50, s50, 1056768
    s_add_u32 m0, s51, 0
    s_waitcnt lgkmcnt(3)
    v_mfma_f32_32x32x16_bf16 v[36:51], a[32:35], v[72:75], v[36:51]
    ds_read_b128 v[88:91], v16 offset:32768
    ds_read_b128 v[84:87], v10 offset:32768
    s_waitcnt lgkmcnt(4)
    v_mfma_f32_32x32x16_bf16 v[20:35], a[32:35], v[68:71], v[20:35]
    ds_read_b128 v[96:99], v17 offset:32768
    ds_read_b128 v[92:95], v11 offset:32768
    buffer_load_dwordx4 v100, s[28:31], s50 offen offset:0 lds
    s_waitcnt lgkmcnt(5)
    v_mfma_f32_32x32x16_bf16 v[36:51], a[36:39], v[80:83], v[36:51]
    s_waitcnt lgkmcnt(4)
    v_mfma_f32_32x32x16_bf16 v[20:35], a[36:39], v[76:79], v[20:35]
    s_waitcnt lgkmcnt(3)
    v_mfma_f32_32x32x16_bf16 v[36:51], a[40:43], v[88:91], v[36:51]
    buffer_load_dwordx4 v101, s[28:31], s50 offen offset:1024 lds
    s_waitcnt lgkmcnt(2)
    v_mfma_f32_32x32x16_bf16 v[20:35], a[40:43], v[84:87], v[20:35]
    s_waitcnt vmcnt(6)
    s_barrier
    s_waitcnt lgkmcnt(1)
    v_mfma_f32_32x32x16_bf16 v[36:51], a[44:47], v[96:99], v[36:51]
    ds_read_b128 v[72:75], v4 offset:49152
    ds_read_b128 v[68:71], v8 offset:49152
    s_waitcnt lgkmcnt(2)
    v_mfma_f32_32x32x16_bf16 v[20:35], a[44:47], v[92:95], v[20:35]
    ds_read_b128 v[80:83], v5 offset:49152
    ds_read_b128 v[76:79], v9 offset:49152
    buffer_load_dwordx4 v102, s[28:31], s50 offen offset:2048 lds
    s_add_u32 s74, s74, 1
    s_and_b32 s74, s74, 3
    s_mul_i32 s50, s74, 88064
    s_waitcnt lgkmcnt(3)
    v_mfma_f32_32x32x16_bf16 v[36:51], a[48:51], v[72:75], v[36:51]
    ds_read_b128 v[88:91], v16 offset:49152
    ds_read_b128 v[84:87], v10 offset:49152
    s_add_u32 s50, s50, s64
    s_mul_i32 s51, s74, 3072
    s_add_u32 s51, s51, s65
    s_add_u32 s50, s50, 1056768
    s_waitcnt lgkmcnt(4)
    v_mfma_f32_32x32x16_bf16 v[20:35], a[48:51], v[68:71], v[20:35]
    ds_read_b128 v[96:99], v17 offset:49152
    ds_read_b128 v[92:95], v11 offset:49152
    s_add_u32 m0, s51, 0
    s_waitcnt lgkmcnt(5)
    v_mfma_f32_32x32x16_bf16 v[36:51], a[52:55], v[80:83], v[36:51]
    buffer_load_dwordx4 v100, s[28:31], s50 offen offset:0 lds
    s_waitcnt lgkmcnt(4)
    v_mfma_f32_32x32x16_bf16 v[20:35], a[52:55], v[76:79], v[20:35]
    s_waitcnt lgkmcnt(3)
    v_mfma_f32_32x32x16_bf16 v[36:51], a[56:59], v[88:91], v[36:51]
    s_waitcnt lgkmcnt(1)
    v_mfma_f32_32x32x16_bf16 v[36:51], a[60:63], v[96:99], v[36:51]
    buffer_load_dwordx4 v101, s[28:31], s50 offen offset:1024 lds
    v_mfma_f32_32x32x16_bf16 v[20:35], a[56:59], v[84:87], v[20:35]
    s_waitcnt lgkmcnt(0)
    v_mfma_f32_32x32x16_bf16 v[20:35], a[60:63], v[92:95], v[20:35]
    s_nop 7
    ds_write_b128 v12, v[36:39] offset:0
    ds_write_b128 v12, v[40:43] offset:1024
    ds_write_b128 v12, v[44:47] offset:2048
    ds_write_b128 v12, v[48:51] offset:3072
    buffer_load_dwordx4 v102, s[28:31], s50 offen offset:2048 lds
    s_add_u32 s74, s74, 1
    s_and_b32 s74, s74, 3
    s_mul_i32 s50, s74, 88064
    s_add_u32 s50, s50, s64
    s_mul_i32 s51, s74, 3072
    s_add_u32 s51, s51, s65
    s_add_u32 s50, s50, 1056768
    s_add_u32 m0, s51, 0
    s_nop 0
    buffer_load_dwordx4 v100, s[28:31], s50 offen offset:0 lds
    s_waitcnt lgkmcnt(0)
    s_barrier
    ds_read_b128 v[36:39], v13 offset:0
    ds_read_b128 v[40:43], v13 offset:1024
    ds_read_b128 v[44:47], v13 offset:2048
    ds_read_b128 v[48:51], v13 offset:3072
    buffer_load_dwordx4 v101, s[28:31], s50 offen offset:1024 lds
    s_waitcnt lgkmcnt(3)
    v_pk_add_f32 v[20:21], v[20:21], v[36:37]
    v_pk_add_f32 v[22:23], v[22:23], v[38:39]
    s_waitcnt lgkmcnt(2)
    v_pk_add_f32 v[24:25], v[24:25], v[40:41]
    v_pk_add_f32 v[26:27], v[26:27], v[42:43]
    s_waitcnt lgkmcnt(1)
    v_pk_add_f32 v[28:29], v[28:29], v[44:45]
    v_pk_add_f32 v[30:31], v[30:31], v[46:47]
    buffer_load_dwordx4 v102, s[28:31], s50 offen offset:2048 lds
    s_waitcnt lgkmcnt(0)
    v_pk_add_f32 v[32:33], v[32:33], v[48:49]
    v_pk_add_f32 v[34:35], v[34:35], v[50:51]
    v_pk_mul_f32 v[68:69], v[20:21], v[20:21]
    v_pk_mul_f32 v[70:71], v[22:23], v[22:23]
    s_add_u32 s74, s74, 1
    v_pk_mul_f32 v[72:73], v[24:25], v[24:25]
    v_pk_mul_f32 v[74:75], v[26:27], v[26:27]
    v_pk_mul_f32 v[76:77], v[28:29], v[28:29]
    v_pk_mul_f32 v[78:79], v[30:31], v[30:31]
    s_and_b32 s74, s74, 3
    v_pk_mul_f32 v[80:81], v[32:33], v[32:33]
    v_pk_mul_f32 v[82:83], v[34:35], v[34:35]
    v_pk_fma_f32 v[68:69], v[68:69], s[46:47], s[46:47] op_sel:[0,1,0] op_sel_hi:[1,1,0]
    v_pk_fma_f32 v[70:71], v[70:71], s[46:47], s[46:47] op_sel:[0,1,0] op_sel_hi:[1,1,0]
    s_mul_i32 s50, s74, 88064
    v_pk_fma_f32 v[72:73], v[72:73], s[46:47], s[46:47] op_sel:[0,1,0] op_sel_hi:[1,1,0]
    v_pk_fma_f32 v[74:75], v[74:75], s[46:47], s[46:47] op_sel:[0,1,0] op_sel_hi:[1,1,0]
    v_pk_fma_f32 v[76:77], v[76:77], s[46:47], s[46:47] op_sel:[0,1,0] op_sel_hi:[1,1,0]
    v_pk_fma_f32 v[78:79], v[78:79], s[46:47], s[46:47] op_sel:[0,1,0] op_sel_hi:[1,1,0]
    s_add_u32 s50, s50, s64
    v_pk_fma_f32 v[80:81], v[80:81], s[46:47], s[46:47] op_sel:[0,1,0] op_sel_hi:[1,1,0]
    v_pk_fma_f32 v[82:83], v[82:83], s[46:47], s[46:47] op_sel:[0,1,0] op_sel_hi:[1,1,0]
    v_pk_mul_f32 v[68:69], v[68:69], v[20:21]
    v_pk_mul_f32 v[70:71], v[70:71], v[22:23]
    s_mul_i32 s51, s74, 3072
    v_pk_mul_f32 v[72:73], v[72:73], v[24:25]
    v_pk_mul_f32 v[74:75], v[74:75], v[26:27]
    v_pk_mul_f32 v[76:77], v[76:77], v[28:29]
    v_pk_mul_f32 v[78:79], v[78:79], v[30:31]
    s_add_u32 s51, s51, s65
    v_pk_mul_f32 v[80:81], v[80:81], v[32:33]
    v_pk_mul_f32 v[82:83], v[82:83], v[34:35]
    v_exp_f32 v68, v68
    v_exp_f32 v70, v70
    s_add_u32 s50, s50, 1056768
    v_exp_f32 v72, v72
    v_exp_f32 v74, v74
    v_exp_f32 v76, v76
    v_exp_f32 v78, v78
    s_add_u32 m0, s51, 0
    v_exp_f32 v80, v80
    v_exp_f32 v82, v82
    v_exp_f32 v69, v69
    v_exp_f32 v71, v71
    buffer_load_dwordx4 v100, s[28:31], s50 offen offset:0 lds
    v_exp_f32 v73, v73
    v_exp_f32 v75, v75
    v_exp_f32 v77, v77
    v_exp_f32 v79, v79
    v_exp_f32 v81, v81
    v_exp_f32 v83, v83
    v_pk_add_f32 v[68:69], v[68:69], 1.0 op_sel_hi:[1,0]
    v_pk_add_f32 v[70:71], v[70:71], 1.0 op_sel_hi:[1,0]
    v_pk_add_f32 v[72:73], v[72:73], 1.0 op_sel_hi:[1,0]
    v_pk_add_f32 v[74:75], v[74:75], 1.0 op_sel_hi:[1,0]
    v_pk_add_f32 v[76:77], v[76:77], 1.0 op_sel_hi:[1,0]
    v_pk_add_f32 v[78:79], v[78:79], 1.0 op_sel_hi:[1,0]
    v_pk_add_f32 v[80:81], v[80:81], 1.0 op_sel_hi:[1,0]
    v_pk_add_f32 v[82:83], v[82:83], 1.0 op_sel_hi:[1,0]
    v_rcp_f32 v68, v68
    v_rcp_f32 v70, v70
    buffer_load_dwordx4 v101, s[28:31], s50 offen offset:1024 lds
    v_rcp_f32 v72, v72
    v_rcp_f32 v74, v74
    v_rcp_f32 v76, v76
    v_rcp_f32 v78, v78
    v_rcp_f32 v80, v80
    v_rcp_f32 v82, v82
    v_rcp_f32 v69, v69
    v_rcp_f32 v71, v71
    v_rcp_f32 v73, v73
    v_rcp_f32 v75, v75
    v_rcp_f32 v77, v77
    v_rcp_f32 v79, v79
    buffer_load_dwordx4 v102, s[28:31], s50 offen offset:2048 lds
    v_rcp_f32 v81, v81
    v_rcp_f32 v83, v83
    v_pk_mul_f32 v[68:69], v[68:69], v[20:21]
    v_pk_mul_f32 v[70:71], v[70:71], v[22:23]
    v_pk_mul_f32 v[72:73], v[72:73], v[24:25]
    v_pk_mul_f32 v[74:75], v[74:75], v[26:27]
    v_pk_mul_f32 v[76:77], v[76:77], v[28:29]
    v_pk_mul_f32 v[78:79], v[78:79], v[30:31]
    v_pk_mul_f32 v[80:81], v[80:81], v[32:33]
    v_pk_mul_f32 v[82:83], v[82:83], v[34:35]
    v_cvt_pk_bf16_f32 v84, v68, v69
    v_cvt_pk_bf16_f32 v85, v70, v71
    v_cvt_pk_bf16_f32 v86, v72, v73
    v_cvt_pk_bf16_f32 v87, v74, v75
    v_cvt_pk_bf16_f32 v88, v76, v77
    v_cvt_pk_bf16_f32 v89, v78, v79
    v_cvt_pk_bf16_f32 v90, v80, v81
    v_cvt_pk_bf16_f32 v91, v82, v83
    s_lshl1_add_u32 s45, s4, s7
    s_lshl_b32 s45, s45, 12
    s_lshl_b32 s58, s6, 10
    s_add_u32 s45, s45, s58
    s_cmp_eq_u32 s44, 1
    s_cbranch_scc0 ALT_19
    buffer_store_dwordx4 v[84:87], v2, s[24:27], s45 offen
    buffer_store_dwordx4 v[88:91], v2, s[24:27], s45 offen offset:2048
ALTE_20:
    s_mul_i32 s58, s6, 33792
    v_add_u32 v4, s58, v2
    v_xor_b32 v5, 1024, v4
    s_lshl_b32 s58, s6, 15
    s_lshl_b32 s57, s7, 12
    s_add_u32 s58, s58, s57
    s_add_u32 s20, s20, 2048
    s_addc_u32 s21, s21, 0
    s_mov_b32 s22, 65536
    s_waitcnt vmcnt(0)
    buffer_store_dword v19, v0, s[36:39], s78 offen offset:128
    buffer_store_dword v19, v0, s[36:39], s79 offen offset:128 sc1
    s_barrier
    ds_read_b64_tr_b16 a[112:113], v128 offset:0
    ds_read_b64_tr_b16 a[114:115], v128 offset:24576
    ds_read_b64_tr_b16 a[176:177], v129 offset:0
    ds_read_b64_tr_b16 a[178:179], v129 offset:24576
    ds_read_b64_tr_b16 a[240:241], v130 offset:0
    ds_read_b64_tr_b16 a[242:243], v130 offset:24576
    ds_read_b64_tr_b16 a[116:117], v128 offset:3072
    ds_read_b64_tr_b16 a[118:119], v128 offset:27648
    ds_read_b64_tr_b16 a[180:181], v129 offset:3072
    ds_read_b64_tr_b16 a[182:183], v129 offset:27648
    ds_read_b64_tr_b16 a[244:245], v130 offset:3072
    ds_read_b64_tr_b16 a[246:247], v130 offset:27648
    ds_read_b64_tr_b16 a[120:121], v128 offset:6144
    ds_read_b64_tr_b16 a[122:123], v128 offset:30720
    ds_read_b64_tr_b16 a[184:185], v129 offset:6144
    ds_read_b64_tr_b16 a[186:187], v129 offset:30720
    ds_read_b64_tr_b16 a[248:249], v130 offset:6144
    ds_read_b64_tr_b16 a[250:251], v130 offset:30720
    ds_read_b64_tr_b16 a[124:125], v128 offset:9216
    ds_read_b64_tr_b16 a[126:127], v128 offset:33792
    ds_read_b64_tr_b16 a[188:189], v129 offset:9216
    ds_read_b64_tr_b16 a[190:191], v129 offset:33792
    ds_read_b64_tr_b16 a[252:253], v130 offset:9216
    ds_read_b64_tr_b16 a[254:255], v130 offset:33792
    v_mov_b32 v72, 0x3f803f80
    v_mov_b32 v73, 0x3f803f80
    v_mov_b32 v74, 0x3f803f80
    v_mov_b32 v75, 0x3f803f80
    s_nop 1
    v_mfma_f32_16x16x32_bf16 v[132:135], a[96:99], v[72:75], v[132:135]
    v_mfma_f32_16x16x32_bf16 v[136:139], a[160:163], v[72:75], v[136:139]
    v_mfma_f32_16x16x32_bf16 v[140:143], a[224:227], v[72:75], v[140:143]
    v_mfma_f32_16x16x32_bf16 v[132:135], a[100:103], v[72:75], v[132:135]
    v_mfma_f32_16x16x32_bf16 v[136:139], a[164:167], v[72:75], v[136:139]
    v_mfma_f32_16x16x32_bf16 v[140:143], a[228:231], v[72:75], v[140:143]
    v_mfma_f32_16x16x32_bf16 v[132:135], a[104:107], v[72:75], v[132:135]
    v_mfma_f32_16x16x32_bf16 v[136:139], a[168:171], v[72:75], v[136:139]
    v_mfma_f32_16x16x32_bf16 v[140:143], a[232:235], v[72:75], v[140:143]
    v_mfma_f32_16x16x32_bf16 v[132:135], a[108:111], v[72:75], v[132:135]
    v_mfma_f32_16x16x32_bf16 v[136:139], a[172:175], v[72:75], v[136:139]
    v_mfma_f32_16x16x32_bf16 v[140:143], a[236:239], v[72:75], v[140:143]
    s_mov_b32 s49, 0
POLL_21:
    buffer_load_dword v14, v3, s[36:39], s66 offen offset:128 sc1
    s_add_u32 s49, s49, 1
    s_cmp_gt_u32 s49, 0x200000
    s_cbranch_scc1 POLLE_22
    s_waitcnt vmcnt(0)
    v_cmp_ne_u32 vcc, s67, v14
    s_nop 0
    s_cbranch_vccnz POLL_21
POLLE_22:
    s_waitcnt vmcnt(0)
    s_mov_b32 m0, s58
    s_nop 0
    buffer_load_dwordx4 v2, s[24:27], s58 offen offset:0 sc1 lds
    buffer_load_dwordx4 v2, s[24:27], s58 offen offset:1024 sc1 lds
    buffer_load_dwordx4 v2, s[24:27], s58 offen offset:2048 sc1 lds
    buffer_load_dwordx4 v2, s[24:27], s58 offen offset:3072 sc1 lds
    s_add_u32 s58, s58, 8192
    s_mov_b32 m0, s58
    s_nop 0
    buffer_load_dwordx4 v2, s[24:27], s58 offen offset:0 sc1 lds
    buffer_load_dwordx4 v2, s[24:27], s58 offen offset:1024 sc1 lds
    buffer_load_dwordx4 v2, s[24:27], s58 offen offset:2048 sc1 lds
    buffer_load_dwordx4 v2, s[24:27], s58 offen offset:3072 sc1 lds
    s_add_u32 s58, s58, 8192
    s_mov_b32 m0, s58
    s_nop 0
    buffer_load_dwordx4 v2, s[24:27], s58 offen offset:0 sc1 lds
    buffer_load_dwordx4 v2, s[24:27], s58 offen offset:1024 sc1 lds
    buffer_load_dwordx4 v2, s[24:27], s58 offen offset:2048 sc1 lds
    buffer_load_dwordx4 v2, s[24:27], s58 offen offset:3072 sc1 lds
    s_waitcnt vmcnt(8)
    s_waitcnt lgkmcnt(0)
    s_barrier
    ds_read_b128 v[72:75], v5 offset:0
    ds_read_b128 v[68:71], v4 offset:0
    ds_read_b128 v[80:83], v5 offset:2048
    ds_read_b128 v[76:79], v4 offset:2048
    ds_read_b128 v[88:91], v5 offset:4096
    ds_read_b128 v[84:87], v4 offset:4096
    s_waitcnt lgkmcnt(5)
    v_mfma_f32_32x32x16_bf16 v[36:51], v[192:195], v[72:75], 0
    ds_read_b128 v[96:99], v5 offset:6144
    ds_read_b128 v[92:95], v4 offset:6144
    s_add_u32 s58, s58, 8192
    s_mov_b32 m0, s58
    s_nop 0
    buffer_load_dwordx4 v2, s[24:27], s58 offen offset:0 sc1 lds
    s_waitcnt lgkmcnt(6)
    v_mfma_f32_32x32x16_bf16 v[20:35], v[192:195], v[68:71], 0
    s_waitcnt lgkmcnt(5)
    v_mfma_f32_32x32x16_bf16 v[36:51], v[196:199], v[80:83], v[36:51]
    buffer_load_dwordx4 v2, s[24:27], s58 offen offset:1024 sc1 lds
    s_waitcnt lgkmcnt(4)
    v_mfma_f32_32x32x16_bf16 v[20:35], v[196:199], v[76:79], v[20:35]
    s_waitcnt lgkmcnt(3)
    v_mfma_f32_32x32x16_bf16 v[36:51], v[200:203], v[88:91], v[36:51]
    buffer_load_dwordx4 v2, s[24:27], s58 offen offset:2048 sc1 lds
    s_waitcnt lgkmcnt(2)
    v_mfma_f32_32x32x16_bf16 v[20:35], v[200:203], v[84:87], v[20:35]
    s_waitcnt vmcnt(7)
    s_barrier
    s_waitcnt lgkmcnt(1)
    v_mfma_f32_32x32x16_bf16 v[36:51], v[204:207], v[96:99], v[36:51]
    ds_read_b128 v[72:75], v5 offset:8192
    ds_read_b128 v[68:71], v4 offset:8192
    buffer_load_dwordx4 v2, s[24:27], s58 offen offset:3072 sc1 lds
    s_mov_b64 s[28:29], s[34:35]
    s_mov_b32 s30, 1409024
    s_mul_i32 s64, s6, 704512
    s_waitcnt lgkmcnt(2)
    v_mfma_f32_32x32x16_bf16 v[20:35], v[204:207], v[92:95], v[20:35]
    ds_read_b128 v[80:83], v5 offset:10240
    ds_read_b128 v[76:79], v4 offset:10240
    s_add_u32 s64, s64, s75
    s_mov_b32 s50, s64
    s_mov_b32 s51, s65
    s_add_u32 m0, s51, 0
    s_waitcnt lgkmcnt(3)
    v_mfma_f32_32x32x16_bf16 v[36:51], v[208:211], v[72:75], v[36:51]
    ds_read_b128 v[88:91], v5 offset:12288
    ds_read_b128 v[84:87], v4 offset:12288
    s_waitcnt lgkmcnt(4)
    v_mfma_f32_32x32x16_bf16 v[20:35], v[208:211], v[68:71], v[20:35]
    ds_read_b128 v[96:99], v5 offset:14336
    ds_read_b128 v[92:95], v4 offset:14336
    buffer_load_dwordx4 v147, s[28:31], s50 offen offset:0 lds
    s_add_u32 s50, s50, 15360
    s_waitcnt lgkmcnt(5)
    v_mfma_f32_32x32x16_bf16 v[36:51], v[212:215], v[80:83], v[36:51]
    s_waitcnt lgkmcnt(4)
    v_mfma_f32_32x32x16_bf16 v[20:35], v[212:215], v[76:79], v[20:35]
    s_waitcnt lgkmcnt(3)
    v_mfma_f32_32x32x16_bf16 v[36:51], v[216:219], v[88:91], v[36:51]
    buffer_load_dwordx4 v147, s[28:31], s50 offen offset:1024 lds
    s_add_u32 s50, s50, 15360
    s_waitcnt lgkmcnt(2)
    v_mfma_f32_32x32x16_bf16 v[20:35], v[216:219], v[84:87], v[20:35]
    s_waitcnt vmcnt(6)
    s_barrier
    s_waitcnt lgkmcnt(1)
    v_mfma_f32_32x32x16_bf16 v[36:51], v[220:223], v[96:99], v[36:51]
    ds_read_b128 v[72:75], v5 offset:16384
    ds_read_b128 v[68:71], v4 offset:16384
    s_waitcnt lgkmcnt(2)
    v_mfma_f32_32x32x16_bf16 v[20:35], v[220:223], v[92:95], v[20:35]
    ds_read_b128 v[80:83], v5 offset:18432
    ds_read_b128 v[76:79], v4 offset:18432
    buffer_load_dwordx4 v147, s[28:31], s50 offen offset:2048 lds
    s_add_u32 s50, s50, 15360
    s_waitcnt lgkmcnt(3)
    v_mfma_f32_32x32x16_bf16 v[36:51], v[224:227], v[72:75], v[36:51]
    ds_read_b128 v[88:91], v5 offset:20480
    ds_read_b128 v[84:87], v4 offset:20480
    s_waitcnt lgkmcnt(4)
    v_mfma_f32_32x32x16_bf16 v[20:35], v[224:227], v[68:71], v[20:35]
    ds_read_b128 v[96:99], v5 offset:22528
    ds_read_b128 v[92:95], v4 offset:22528
    s_waitcnt lgkmcnt(5)
    v_mfma_f32_32x32x16_bf16 v[36:51], v[228:231], v[80:83], v[36:51]
    buffer_load_dwordx4 v147, s[28:31], s50 offen offset:3072 lds
    s_waitcnt lgkmcnt(4)
    v_mfma_f32_32x32x16_bf16 v[20:35], v[228:231], v[76:79], v[20:35]
    s_waitcnt lgkmcnt(3)
    v_mfma_f32_32x32x16_bf16 v[36:51], v[232:235], v[88:91], v[36:51]
    s_waitcnt lgkmcnt(2)
    v_mfma_f32_32x32x16_bf16 v[20:35], v[232:235], v[84:87], v[20:35]
    s_waitcnt vmcnt(4)
    s_barrier
    s_waitcnt lgkmcnt(1)
    v_mfma_f32_32x32x16_bf16 v[36:51], v[236:239], v[96:99], v[36:51]
    ds_read_b128 v[72:75], v5 offset:24576
    ds_read_b128 v[68:71], v4 offset:24576
    s_waitcnt lgkmcnt(2)
    v_mfma_f32_32x32x16_bf16 v[20:35], v[236:239], v[92:95], v[20:35]
    ds_read_b128 v[80:83], v5 offset:26624
    ds_read_b128 v[76:79], v4 offset:26624
    s_waitcnt lgkmcnt(3)
    v_mfma_f32_32x32x16_bf16 v[36:51], v[240:243], v[72:75], v[36:51]
    ds_read_b128 v[88:91], v5 offset:28672
    ds_read_b128 v[84:87], v4 offset:28672
    s_waitcnt lgkmcnt(4)
    v_mfma_f32_32x32x16_bf16 v[20:35], v[240:243], v[68:71], v[20:35]
    ds_read_b128 v[96:99], v5 offset:30720
    ds_read_b128 v[92:95], v4 offset:30720
    s_waitcnt lgkmcnt(5)
    v_mfma_f32_32x32x16_bf16 v[36:51], v[244:247], v[80:83], v[36:51]
    s_waitcnt lgkmcnt(4)
    v_mfma_f32_32x32x16_bf16 v[20:35], v[244:247], v[76:79], v[20:35]
    s_waitcnt lgkmcnt(3)
    v_mfma_f32_32x32x16_bf16 v[36:51], v[248:251], v[88:91], v[36:51]
    s_waitcnt lgkmcnt(1)
    v_mfma_f32_32x32x16_bf16 v[36:51], v[252:255], v[96:99], v[36:51]
    v_mfma_f32_32x32x16_bf16 v[20:35], v[248:251], v[84:87], v[20:35]
    s_waitcnt lgkmcnt(0)
    v_mfma_f32_32x32x16_bf16 v[20:35], v[252:255], v[92:95], v[20:35]
    v_lshlrev_b32 v68, 16, v116
    v_and_b32 v69, 0xffff0000, v116
    v_lshlrev_b32 v70, 16, v117
    v_and_b32 v71, 0xffff0000, v117
    v_lshlrev_b32 v72, 16, v118
    v_and_b32 v73, 0xffff0000, v118
    v_lshlrev_b32 v74, 16, v119
    v_and_b32 v75, 0xffff0000, v119
    v_lshlrev_b32 v76, 16, v120
    v_and_b32 v77, 0xffff0000, v120
    v_lshlrev_b32 v78, 16, v121
    v_and_b32 v79, 0xffff0000, v121
    v_lshlrev_b32 v80, 16, v122
    v_and_b32 v81, 0xffff0000, v122
    v_lshlrev_b32 v82, 16, v123
    s_nop 0
    v_and_b32 v83, 0xffff0000, v123
    v_pk_mul_f32 v[68:69], v[68:69], v[126:127] op_sel_hi:[1,0]
    v_pk_mul_f32 v[70:71], v[70:71], v[126:127] op_sel_hi:[1,0]
    v_pk_mul_f32 v[72:73], v[72:73], v[126:127] op_sel_hi:[1,0]
    v_pk_mul_f32 v[74:75], v[74:75], v[126:127] op_sel_hi:[1,0]
    v_pk_mul_f32 v[76:77], v[76:77], v[126:127] op_sel_hi:[1,0]
    v_pk_mul_f32 v[78:79], v[78:79], v[126:127] op_sel_hi:[1,0]
    v_pk_mul_f32 v[80:81], v[80:81], v[126:127] op_sel_hi:[1,0]
    v_pk_mul_f32 v[82:83], v[82:83], v[126:127] op_sel_hi:[1,0]
    ds_write_b128 v12, v[36:39] offset:0
    ds_write_b128 v12, v[40:43] offset:1024
    ds_write_b128 v12, v[44:47] offset:2048
    ds_write_b128 v12, v[48:51] offset:3072
    s_waitcnt lgkmcnt(0)
    s_barrier
    ds_read_b128 v[36:39], v13 offset:0
    ds_read_b128 v[40:43], v13 offset:1024
    ds_read_b128 v[44:47], v13 offset:2048
    ds_read_b128 v[48:51], v13 offset:3072
    s_waitcnt lgkmcnt(3)
    v_pk_add_f32 v[20:21], v[20:21], v[36:37]
    v_pk_add_f32 v[22:23], v[22:23], v[38:39]
    s_waitcnt lgkmcnt(2)
    v_pk_add_f32 v[24:25], v[24:25], v[40:41]
    v_pk_add_f32 v[26:27], v[26:27], v[42:43]
    s_waitcnt lgkmcnt(1)
    v_pk_add_f32 v[28:29], v[28:29], v[44:45]
    v_pk_add_f32 v[30:31], v[30:31], v[46:47]
    s_waitcnt lgkmcnt(0)
    v_pk_add_f32 v[32:33], v[32:33], v[48:49]
    v_pk_add_f32 v[34:35], v[34:35], v[50:51]
    v_pk_add_f32 v[20:21], v[20:21], v[68:69]
    v_pk_add_f32 v[22:23], v[22:23], v[70:71]
    v_pk_add_f32 v[24:25], v[24:25], v[72:73]
    v_pk_add_f32 v[26:27], v[26:27], v[74:75]
    v_pk_add_f32 v[28:29], v[28:29], v[76:77]
    v_pk_add_f32 v[30:31], v[30:31], v[78:79]
    v_pk_add_f32 v[32:33], v[32:33], v[80:81]
    v_pk_add_f32 v[34:35], v[34:35], v[82:83]
    v_cvt_pk_bf16_f32 v84, v20, v21
    v_cvt_pk_bf16_f32 v85, v22, v23
    v_cvt_pk_bf16_f32 v86, v24, v25
    v_cvt_pk_bf16_f32 v87, v26, v27
    v_cvt_pk_bf16_f32 v88, v28, v29
    v_cvt_pk_bf16_f32 v89, v30, v31
    v_cvt_pk_bf16_f32 v90, v32, v33
    v_cvt_pk_bf16_f32 v91, v34, v35
    s_cmp_eq_u32 s44, 1
    s_cbranch_scc0 ALT_23
    buffer_store_dwordx4 v[84:87], v2, s[20:23], s45 offen
    buffer_store_dwordx4 v[88:91], v2, s[20:23], s45 offen offset:2048
ALTE_24:
    v_lshlrev_b32 v20, 16, v84
    v_and_b32 v21, 0xffff0000, v84
    v_lshlrev_b32 v22, 16, v85
    v_and_b32 v23, 0xffff0000, v85
    v_lshlrev_b32 v24, 16, v86
    v_and_b32 v25, 0xffff0000, v86
    v_lshlrev_b32 v26, 16, v87
    v_and_b32 v27, 0xffff0000, v87
    v_lshlrev_b32 v28, 16, v88
    v_and_b32 v29, 0xffff0000, v88
    v_lshlrev_b32 v30, 16, v89
    v_and_b32 v31, 0xffff0000, v89
    v_lshlrev_b32 v32, 16, v90
    v_and_b32 v33, 0xffff0000, v90
    v_lshlrev_b32 v34, 16, v91
    v_and_b32 v35, 0xffff0000, v91
    v_pk_add_f32 v[36:37], v[20:21], v[22:23]
    v_pk_mul_f32 v[38:39], v[20:21], v[20:21]
    v_pk_fma_f32 v[38:39], v[22:23], v[22:23], v[38:39]
    v_pk_add_f32 v[36:37], v[36:37], v[24:25]
    v_pk_fma_f32 v[38:39], v[24:25], v[24:25], v[38:39]
    v_pk_add_f32 v[36:37], v[36:37], v[26:27]
    v_pk_fma_f32 v[38:39], v[26:27], v[26:27], v[38:39]
    v_pk_add_f32 v[36:37], v[36:37], v[28:29]
    v_pk_fma_f32 v[38:39], v[28:29], v[28:29], v[38:39]
    v_pk_add_f32 v[36:37], v[36:37], v[30:31]
    v_pk_fma_f32 v[38:39], v[30:31], v[30:31], v[38:39]
    v_pk_add_f32 v[36:37], v[36:37], v[32:33]
    v_pk_fma_f32 v[38:39], v[32:33], v[32:33], v[38:39]
    v_pk_add_f32 v[36:37], v[36:37], v[34:35]
    v_pk_fma_f32 v[38:39], v[34:35], v[34:35], v[38:39]
    v_add_f32 v36, v36, v37
    v_add_f32 v38, v38, v39
    v_lshlrev_b32 v14, 2, v1
    s_lshr_b32 s57, s45, 3
    s_lshl_b32 s56, s6, 7
    s_add_u32 s57, s57, s56
    v_permlane32_swap_b32 v36, v38
    s_lshl_b32 s56, s3, 13
    s_add_u32 s56, s56, 0x10000
    s_add_u32 s57, s57, s56
    v_add_f32 v36, v36, v38
    s_cmp_eq_u32 s44, 1
    s_cbranch_scc0 ALT_25
    buffer_store_dword v36, v14, s[36:39], s57 offen
ALTE_26:
    v_pk_fma_f32 v[68:69], v[68:69], v[124:125], v[124:125] op_sel:[0,1,0] op_sel_hi:[1,1,0]
    v_pk_fma_f32 v[70:71], v[70:71], v[124:125], v[124:125] op_sel:[0,1,0] op_sel_hi:[1,1,0]
    v_pk_fma_f32 v[72:73], v[72:73], v[124:125], v[124:125] op_sel:[0,1,0] op_sel_hi:[1,1,0]
    v_pk_fma_f32 v[74:75], v[74:75], v[124:125], v[124:125] op_sel:[0,1,0] op_sel_hi:[1,1,0]
    v_pk_fma_f32 v[76:77], v[76:77], v[124:125], v[124:125] op_sel:[0,1,0] op_sel_hi:[1,1,0]
    v_pk_fma_f32 v[78:79], v[78:79], v[124:125], v[124:125] op_sel:[0,1,0] op_sel_hi:[1,1,0]
    v_pk_fma_f32 v[80:81], v[80:81], v[124:125], v[124:125] op_sel:[0,1,0] op_sel_hi:[1,1,0]
    v_pk_fma_f32 v[82:83], v[82:83], v[124:125], v[124:125] op_sel:[0,1,0] op_sel_hi:[1,1,0]
    v_pk_add_f32 v[100:101], v[20:21], v[68:69]
    v_pk_add_f32 v[102:103], v[22:23], v[70:71]
    v_pk_add_f32 v[104:105], v[24:25], v[72:73]
    v_pk_add_f32 v[106:107], v[26:27], v[74:75]
    v_pk_add_f32 v[108:109], v[28:29], v[76:77]
    v_pk_add_f32 v[110:111], v[30:31], v[78:79]
    v_pk_add_f32 v[112:113], v[32:33], v[80:81]
    v_pk_add_f32 v[114:115], v[34:35], v[82:83]
    v_and_b32 v15, 15, v1
    v_lshrrev_b32 v16, 4, v1
    v_lshrrev_b32 v17, 1, v16
    v_lshlrev_b32 v8, 11, v17
    v_lshlrev_b32 v9, 9, v17
    v_and_b32 v17, 1, v16
    v_lshl_add_u32 v8, v17, 9, v8
    v_lshl_add_u32 v8, v15, 4, v8
    v_lshl_add_u32 v9, v17, 3, v9
    v_lshl_add_u32 v9, v15, 4, v9
    v_lshlrev_b32 v10, 11, v16
    v_lshl_add_u32 v10, v15, 2, v10
    s_lshl_b32 s57, s6, 8
    s_lshl_b32 s55, s7, 6
    s_add_u32 s57, s57, s55
    s_add_u32 s55, s57, s56
    v_lshlrev_b32 v11, 4, v15
    v_add_u32 v11, 86016, v11
    s_lshl_b32 s57, s5, 8
    v_add_u32 v9, s57, v11
    v_mov_b32 v72, 0x3f803f80
    v_mov_b32 v73, 0x3f803f80
    v_mov_b32 v74, 0x3f803f80
    v_mov_b32 v75, 0x3f803f80
    s_nop 1
    v_mfma_f32_16x16x32_bf16 v[132:135], a[112:115], v[72:75], v[132:135]
    v_mfma_f32_16x16x32_bf16 v[136:139], a[176:179], v[72:75], v[136:139]
    v_mfma_f32_16x16x32_bf16 v[140:143], a[240:243], v[72:75], v[140:143]
    v_mfma_f32_16x16x32_bf16 v[132:135], a[116:119], v[72:75], v[132:135]
    v_mfma_f32_16x16x32_bf16 v[136:139], a[180:183], v[72:75], v[136:139]
    v_mfma_f32_16x16x32_bf16 v[140:143], a[244:247], v[72:75], v[140:143]
    v_mfma_f32_16x16x32_bf16 v[132:135], a[120:123], v[72:75], v[132:135]
    v_mfma_f32_16x16x32_bf16 v[136:139], a[184:187], v[72:75], v[136:139]
    v_mfma_f32_16x16x32_bf16 v[140:143], a[248:251], v[72:75], v[140:143]
    v_mfma_f32_16x16x32_bf16 v[132:135], a[124:127], v[72:75], v[132:135]
    v_mfma_f32_16x16x32_bf16 v[136:139], a[188:191], v[72:75], v[136:139]
    v_mfma_f32_16x16x32_bf16 v[140:143], a[252:255], v[72:75], v[140:143]
    s_waitcnt vmcnt(0)
    buffer_store_dword v19, v0, s[36:39], s78 offen offset:256
    buffer_store_dword v19, v0, s[36:39], s79 offen offset:256 sc1
    s_barrier
    ds_read_b64_tr_b16 v[148:149], v146 offset:0
    ds_read_b64_tr_b16 v[150:151], v146 offset:256
    ds_read_b64_tr_b16 v[152:153], v146 offset:1024
    ds_read_b64_tr_b16 v[154:155], v146 offset:1280
    ds_read_b64_tr_b16 v[156:157], v146 offset:2048
    ds_read_b64_tr_b16 v[158:159], v146 offset:2304
    ds_read_b64_tr_b16 v[160:161], v146 offset:3072
    ds_read_b64_tr_b16 v[162:163], v146 offset:3328
    s_mov_b32 s49, 0
POLL_27:
    buffer_load_dword v14, v3, s[36:39], s66 offen offset:256 sc1
    s_add_u32 s49, s49, 1
    s_cmp_gt_u32 s49, 0x200000
    s_cbranch_scc1 POLLE_28
    s_waitcnt vmcnt(0)
    v_cmp_ne_u32 vcc, s67, v14
    s_nop 0
    s_cbranch_vccnz POLL_27
POLLE_28:
    s_waitcnt vmcnt(0)
    s_lshl_b32 s58, s5, 12
    s_mov_b32 m0, s58
    s_nop 0
    buffer_load_dwordx4 v2, s[20:23], s58 offen offset:0 sc1 lds
    buffer_load_dwordx4 v2, s[20:23], s58 offen offset:1024 sc1 lds
    buffer_load_dwordx4 v2, s[20:23], s58 offen offset:2048 sc1 lds
    buffer_load_dwordx4 v2, s[20:23], s58 offen offset:3072 sc1 lds
    s_add_u32 s58, s58, 16384
    s_mov_b32 m0, s58
    s_nop 0
    buffer_load_dwordx4 v2, s[20:23], s58 offen offset:0 sc1 lds
    buffer_load_dwordx4 v2, s[20:23], s58 offen offset:1024 sc1 lds
    buffer_load_dwordx4 v2, s[20:23], s58 offen offset:2048 sc1 lds
    buffer_load_dwordx4 v2, s[20:23], s58 offen offset:3072 sc1 lds
    s_waitcnt vmcnt(4)
    s_waitcnt lgkmcnt(0)
    s_barrier
    ds_read_b128 v[68:71], v8 offset:0
    ds_read_b128 v[72:75], v8 offset:256
    ds_read_b128 v[76:79], v8 offset:1024
    ds_read_b128 v[80:83], v8 offset:1280
    s_waitcnt lgkmcnt(3)
    v_mfma_f32_16x16x32_bf16 v[20:23], a[64:67], v[68:71], 0
    ds_read_b128 v[84:87], v8 offset:4096
    s_add_u32 s58, s58, 16384
    v_mfma_f32_16x16x32_bf16 v[36:39], a[128:131], v[68:71], 0
    ds_read_b128 v[88:91], v8 offset:4352
    s_mov_b32 m0, s58
    v_mfma_f32_16x16x32_bf16 v[52:55], a[192:195], v[68:71], 0
    ds_read_b128 v[92:95], v8 offset:5120
    buffer_load_dwordx4 v2, s[20:23], s58 offen offset:0 sc1 lds
    s_waitcnt lgkmcnt(5)
    v_mfma_f32_16x16x32_bf16 v[24:27], a[64:67], v[72:75], 0
    ds_read_b128 v[96:99], v8 offset:5376
    v_mfma_f32_16x16x32_bf16 v[40:43], a[128:131], v[72:75], 0
    v_mfma_f32_16x16x32_bf16 v[56:59], a[192:195], v[72:75], 0
    buffer_load_dwordx4 v2, s[20:23], s58 offen offset:1024 sc1 lds
    s_waitcnt lgkmcnt(5)
    v_mfma_f32_16x16x32_bf16 v[28:31], a[64:67], v[76:79], 0
    v_mfma_f32_16x16x32_bf16 v[44:47], a[128:131], v[76:79], 0
    v_mfma_f32_16x16x32_bf16 v[60:63], a[192:195], v[76:79], 0
    buffer_load_dwordx4 v2, s[20:23], s58 offen offset:2048 sc1 lds
    s_waitcnt lgkmcnt(4)
    v_mfma_f32_16x16x32_bf16 v[32:35], a[64:67], v[80:83], 0
    v_mfma_f32_16x16x32_bf16 v[48:51], a[128:131], v[80:83], 0
    v_mfma_f32_16x16x32_bf16 v[64:67], a[192:195], v[80:83], 0
    s_waitcnt lgkmcnt(0)
    buffer_load_dwordx4 v2, s[20:23], s58 offen offset:3072 sc1 lds
    s_add_u32 s58, s58, 16384
    v_mfma_f32_16x16x32_bf16 v[20:23], a[68:71], v[84:87], v[20:23]
    ds_read_b128 v[68:71], v8 offset:8192
    s_mov_b32 m0, s58
    v_mfma_f32_16x16x32_bf16 v[36:39], a[132:135], v[84:87], v[36:39]
    ds_read_b128 v[72:75], v8 offset:8448
    v_mfma_f32_16x16x32_bf16 v[52:55], a[196:199], v[84:87], v[52:55]
    ds_read_b128 v[76:79], v8 offset:9216
    buffer_load_dwordx4 v2, s[20:23], s58 offen offset:0 sc1 lds
    v_mfma_f32_16x16x32_bf16 v[24:27], a[68:71], v[88:91], v[24:27]
    ds_read_b128 v[80:83], v8 offset:9472
    v_mfma_f32_16x16x32_bf16 v[40:43], a[132:135], v[88:91], v[40:43]
    v_mfma_f32_16x16x32_bf16 v[56:59], a[196:199], v[88:91], v[56:59]
    buffer_load_dwordx4 v2, s[20:23], s58 offen offset:1024 sc1 lds
    v_mfma_f32_16x16x32_bf16 v[28:31], a[68:71], v[92:95], v[28:31]
    v_mfma_f32_16x16x32_bf16 v[44:47], a[132:135], v[92:95], v[44:47]
    v_mfma_f32_16x16x32_bf16 v[60:63], a[196:199], v[92:95], v[60:63]
    buffer_load_dwordx4 v2, s[20:23], s58 offen offset:2048 sc1 lds
    v_mfma_f32_16x16x32_bf16 v[32:35], a[68:71], v[96:99], v[32:35]
    v_mfma_f32_16x16x32_bf16 v[48:51], a[132:135], v[96:99], v[48:51]
    v_mfma_f32_16x16x32_bf16 v[64:67], a[196:199], v[96:99], v[64:67]
    s_waitcnt lgkmcnt(0)
    buffer_load_dwordx4 v2, s[20:23], s58 offen offset:3072 sc1 lds
    v_mfma_f32_16x16x32_bf16 v[20:23], a[72:75], v[68:71], v[20:23]
    ds_read_b128 v[84:87], v8 offset:12288
    v_mfma_f32_16x16x32_bf16 v[36:39], a[136:139], v[68:71], v[36:39]
    ds_read_b128 v[88:91], v8 offset:12544
    v_mfma_f32_16x16x32_bf16 v[52:55], a[200:203], v[68:71], v[52:55]
    ds_read_b128 v[92:95], v8 offset:13312
    buffer_load_dword v116, v10, s[36:39], s55 offen offset:0 sc1
    v_mfma_f32_16x16x32_bf16 v[24:27], a[72:75], v[72:75], v[24:27]
    ds_read_b128 v[96:99], v8 offset:13568
    v_mfma_f32_16x16x32_bf16 v[40:43], a[136:139], v[72:75], v[40:43]
    v_mfma_f32_16x16x32_bf16 v[56:59], a[200:203], v[72:75], v[56:59]
    buffer_load_dword v117, v10, s[36:39], s55 offen offset:128 sc1
    v_mfma_f32_16x16x32_bf16 v[28:31], a[72:75], v[76:79], v[28:31]
    v_mfma_f32_16x16x32_bf16 v[44:47], a[136:139], v[76:79], v[44:47]
    v_mfma_f32_16x16x32_bf16 v[60:63], a[200:203], v[76:79], v[60:63]
    buffer_load_dword v118, v10, s[36:39], s55 offen offset:512 sc1
    v_mfma_f32_16x16x32_bf16 v[32:35], a[72:75], v[80:83], v[32:35]
    v_mfma_f32_16x16x32_bf16 v[48:51], a[136:139], v[80:83], v[48:51]
    v_mfma_f32_16x16x32_bf16 v[64:67], a[200:203], v[80:83], v[64:67]
    s_waitcnt lgkmcnt(0)
    buffer_load_dword v119, v10, s[36:39], s55 offen offset:640 sc1
    v_mfma_f32_16x16x32_bf16 v[20:23], a[76:79], v[84:87], v[20:23]
    v_mfma_f32_16x16x32_bf16 v[36:39], a[140:143], v[84:87], v[36:39]
    v_mfma_f32_16x16x32_bf16 v[52:55], a[204:207], v[84:87], v[52:55]
    buffer_load_dword v120, v10, s[36:39], s55 offen offset:1024 sc1
    v_mfma_f32_16x16x32_bf16 v[24:27], a[76:79], v[88:91], v[24:27]
    s_waitcnt vmcnt(13)
    s_barrier
    v_mfma_f32_16x16x32_bf16 v[40:43], a[140:143], v[88:91], v[40:43]
    ds_read_b128 v[68:71], v8 offset:16384
    v_mfma_f32_16x16x32_bf16 v[56:59], a[204:207], v[88:91], v[56:59]
    ds_read_b128 v[72:75], v8 offset:16640
    buffer_load_dword v121, v10, s[36:39], s55 offen offset:1152 sc1
    v_mfma_f32_16x16x32_bf16 v[28:31], a[76:79], v[92:95], v[28:31]
    ds_read_b128 v[76:79], v8 offset:17408
    v_mfma_f32_16x16x32_bf16 v[44:47], a[140:143], v[92:95], v[44:47]
    ds_read_b128 v[80:83], v8 offset:17664
    v_mfma_f32_16x16x32_bf16 v[60:63], a[204:207], v[92:95], v[60:63]
    buffer_load_dword v122, v10, s[36:39], s55 offen offset:1536 sc1
    v_mfma_f32_16x16x32_bf16 v[32:35], a[76:79], v[96:99], v[32:35]
    v_mfma_f32_16x16x32_bf16 v[48:51], a[140:143], v[96:99], v[48:51]
    v_mfma_f32_16x16x32_bf16 v[64:67], a[204:207], v[96:99], v[64:67]
    s_waitcnt lgkmcnt(0)
    buffer_load_dword v123, v10, s[36:39], s55 offen offset:1664 sc1
    s_mov_b32 s50, s64
    v_mfma_f32_16x16x32_bf16 v[20:23], a[80:83], v[68:71], v[20:23]
    ds_read_b128 v[84:87], v8 offset:20480
    s_mov_b32 s51, s65
    v_mfma_f32_16x16x32_bf16 v[36:39], a[144:147], v[68:71], v[36:39]
    ds_read_b128 v[88:91], v8 offset:20736
    s_add_u32 s50, s50, 65536
    v_mfma_f32_16x16x32_bf16 v[52:55], a[208:211], v[68:71], v[52:55]
    ds_read_b128 v[92:95], v8 offset:21504
    s_add_u32 m0, s51, 0
    v_mfma_f32_16x16x32_bf16 v[24:27], a[80:83], v[72:75], v[24:27]
    ds_read_b128 v[96:99], v8 offset:21760
    buffer_load_dwordx4 v147, s[28:31], s50 offen offset:0 lds
    v_mfma_f32_16x16x32_bf16 v[40:43], a[144:147], v[72:75], v[40:43]
    s_add_u32 s50, s50, 15360
    v_mfma_f32_16x16x32_bf16 v[56:59], a[208:211], v[72:75], v[56:59]
    v_mfma_f32_16x16x32_bf16 v[28:31], a[80:83], v[76:79], v[28:31]
    buffer_load_dwordx4 v147, s[28:31], s50 offen offset:1024 lds
    s_add_u32 s50, s50, 15360
    v_mfma_f32_16x16x32_bf16 v[44:47], a[144:147], v[76:79], v[44:47]
    v_mfma_f32_16x16x32_bf16 v[60:63], a[208:211], v[76:79], v[60:63]
    v_mfma_f32_16x16x32_bf16 v[32:35], a[80:83], v[80:83], v[32:35]
    buffer_load_dwordx4 v147, s[28:31], s50 offen offset:2048 lds
    s_add_u32 s50, s50, 15360
    v_mfma_f32_16x16x32_bf16 v[48:51], a[144:147], v[80:83], v[48:51]
    v_mfma_f32_16x16x32_bf16 v[64:67], a[208:211], v[80:83], v[64:67]
    s_waitcnt lgkmcnt(0)
    v_mfma_f32_16x16x32_bf16 v[20:23], a[84:87], v[84:87], v[20:23]
    ds_read_b128 v[68:71], v8 offset:24576
    buffer_load_dwordx4 v147, s[28:31], s50 offen offset:3072 lds
    v_mfma_f32_16x16x32_bf16 v[36:39], a[148:151], v[84:87], v[36:39]
    ds_read_b128 v[72:75], v8 offset:24832
    s_add_u32 m0, s51, 4096
    v_mfma_f32_16x16x32_bf16 v[52:55], a[212:215], v[84:87], v[52:55]
    ds_read_b128 v[76:79], v8 offset:25600
    s_add_u32 s50, s50, 19456
    v_mfma_f32_16x16x32_bf16 v[24:27], a[84:87], v[88:91], v[24:27]
    ds_read_b128 v[80:83], v8 offset:25856
    buffer_load_dwordx4 v147, s[28:31], s50 offen offset:0 lds
    v_mfma_f32_16x16x32_bf16 v[40:43], a[148:151], v[88:91], v[40:43]
    s_add_u32 s50, s50, 15360
    v_mfma_f32_16x16x32_bf16 v[56:59], a[212:215], v[88:91], v[56:59]
    v_mfma_f32_16x16x32_bf16 v[28:31], a[84:87], v[92:95], v[28:31]
    buffer_load_dwordx4 v147, s[28:31], s50 offen offset:1024 lds
    s_add_u32 s50, s50, 15360
    v_mfma_f32_16x16x32_bf16 v[44:47], a[148:151], v[92:95], v[44:47]
    v_mfma_f32_16x16x32_bf16 v[60:63], a[212:215], v[92:95], v[60:63]
    v_mfma_f32_16x16x32_bf16 v[32:35], a[84:87], v[96:99], v[32:35]
    buffer_load_dwordx4 v147, s[28:31], s50 offen offset:2048 lds
    s_add_u32 s50, s50, 15360
    v_mfma_f32_16x16x32_bf16 v[48:51], a[148:151], v[96:99], v[48:51]
    v_mfma_f32_16x16x32_bf16 v[64:67], a[212:215], v[96:99], v[64:67]
    s_waitcnt lgkmcnt(0)
    v_mfma_f32_16x16x32_bf16 v[20:23], a[88:91], v[68:71], v[20:23]
    ds_read_b128 v[84:87], v8 offset:28672
    buffer_load_dwordx4 v147, s[28:31], s50 offen offset:3072 lds
    v_mfma_f32_16x16x32_bf16 v[36:39], a[152:155], v[68:71], v[36:39]
    ds_read_b128 v[88:91], v8 offset:28928
    s_add_u32 m0, s51, 8192
    v_mfma_f32_16x16x32_bf16 v[52:55], a[216:219], v[68:71], v[52:55]
    ds_read_b128 v[92:95], v8 offset:29696
    s_add_u32 s50, s50, 19456
    v_mfma_f32_16x16x32_bf16 v[24:27], a[88:91], v[72:75], v[24:27]
    ds_read_b128 v[96:99], v8 offset:29952
    buffer_load_dwordx4 v147, s[28:31], s50 offen offset:0 lds
    v_mfma_f32_16x16x32_bf16 v[40:43], a[152:155], v[72:75], v[40:43]
    s_add_u32 s50, s50, 15360
    v_mfma_f32_16x16x32_bf16 v[56:59], a[216:219], v[72:75], v[56:59]
    v_mfma_f32_16x16x32_bf16 v[28:31], a[88:91], v[76:79], v[28:31]
    buffer_load_dwordx4 v147, s[28:31], s50 offen offset:1024 lds
    s_add_u32 s50, s50, 15360
    v_mfma_f32_16x16x32_bf16 v[44:47], a[152:155], v[76:79], v[44:47]
    v_mfma_f32_16x16x32_bf16 v[60:63], a[216:219], v[76:79], v[60:63]
    v_mfma_f32_16x16x32_bf16 v[32:35], a[88:91], v[80:83], v[32:35]
    buffer_load_dwordx4 v147, s[28:31], s50 offen offset:2048 lds
    s_add_u32 s50, s50, 15360
    v_mfma_f32_16x16x32_bf16 v[48:51], a[152:155], v[80:83], v[48:51]
    v_mfma_f32_16x16x32_bf16 v[64:67], a[216:219], v[80:83], v[64:67]
    s_waitcnt lgkmcnt(0)
    v_mfma_f32_16x16x32_bf16 v[20:23], a[92:95], v[84:87], v[20:23]
    buffer_load_dwordx4 v147, s[28:31], s50 offen offset:3072 lds
    s_mov_b32 s50, s64
    v_mfma_f32_16x16x32_bf16 v[36:39], a[156:159], v[84:87], v[36:39]
    s_mov_b32 s51, s65
    s_add_u32 s50, s50, 262144
    v_mfma_f32_16x16x32_bf16 v[52:55], a[220:223], v[84:87], v[52:55]
    s_add_u32 m0, s51, 12288
    v_mfma_f32_16x16x32_bf16 v[24:27], a[92:95], v[88:91], v[24:27]
    s_waitcnt vmcnt(24)
    s_barrier
    buffer_load_dwordx4 v147, s[28:31], s50 offen offset:0 lds
    s_add_u32 s50, s50, 15360
    v_mfma_f32_16x16x32_bf16 v[40:43], a[156:159], v[88:91], v[40:43]
    ds_read_b128 v[68:71], v8 offset:32768
    v_mfma_f32_16x16x32_bf16 v[56:59], a[220:223], v[88:91], v[56:59]
    ds_read_b128 v[72:75], v8 offset:33024
    v_mfma_f32_16x16x32_bf16 v[28:31], a[92:95], v[92:95], v[28:31]
    ds_read_b128 v[76:79], v8 offset:33792
    buffer_load_dwordx4 v147, s[28:31], s50 offen offset:1024 lds
    v_mfma_f32_16x16x32_bf16 v[44:47], a[156:159], v[92:95], v[44:47]
    ds_read_b128 v[80:83], v8 offset:34048
    s_add_u32 s50, s50, 15360
    v_mfma_f32_16x16x32_bf16 v[60:63], a[220:223], v[92:95], v[60:63]
    s_waitcnt vmcnt(19)
    v_add_f32 v116, v116, v118
    v_mfma_f32_16x16x32_bf16 v[32:35], a[92:95], v[96:99], v[32:35]
    s_waitcnt vmcnt(18)
    v_add_f32 v117, v117, v119
    buffer_load_dwordx4 v147, s[28:31], s50 offen offset:2048 lds
    v_mfma_f32_16x16x32_bf16 v[48:51], a[156:159], v[96:99], v[48:51]
    s_waitcnt vmcnt(16)
    v_add_f32 v120, v120, v122
    s_add_u32 s50, s50, 15360
    v_mfma_f32_16x16x32_bf16 v[64:67], a[220:223], v[96:99], v[64:67]
    s_waitcnt vmcnt(15)
    v_add_f32 v121, v121, v123
    s_waitcnt lgkmcnt(0)
    v_mfma_f32_16x16x32_bf16 v[20:23], a[96:99], v[68:71], v[20:23]
    ds_read_b128 v[84:87], v8 offset:36864
    buffer_load_dwordx4 v147, s[28:31], s50 offen offset:3072 lds
    v_mfma_f32_16x16x32_bf16 v[36:39], a[160:163], v[68:71], v[36:39]
    ds_read_b128 v[88:91], v8 offset:37120
    s_add_u32 m0, s51, 16384
    v_mfma_f32_16x16x32_bf16 v[52:55], a[224:227], v[68:71], v[52:55]
    ds_read_b128 v[92:95], v8 offset:37888
    s_add_u32 s50, s50, 19456
    v_mfma_f32_16x16x32_bf16 v[24:27], a[96:99], v[72:75], v[24:27]
    ds_read_b128 v[96:99], v8 offset:38144
    buffer_load_dwordx4 v147, s[28:31], s50 offen offset:0 lds
    v_mfma_f32_16x16x32_bf16 v[40:43], a[160:163], v[72:75], v[40:43]
    v_add_f32 v116, v116, v120
    s_add_u32 s50, s50, 15360
    v_mfma_f32_16x16x32_bf16 v[56:59], a[224:227], v[72:75], v[56:59]
    v_add_f32 v117, v117, v121
    v_mfma_f32_16x16x32_bf16 v[28:31], a[96:99], v[76:79], v[28:31]
    v_mov_b32 v118, v116
    buffer_load_dwordx4 v147, s[28:31], s50 offen offset:1024 lds
    v_mfma_f32_16x16x32_bf16 v[44:47], a[160:163], v[76:79], v[44:47]
    v_mov_b32 v119, v117
    s_add_u32 s50, s50, 15360
    v_mfma_f32_16x16x32_bf16 v[60:63], a[224:227], v[76:79], v[60:63]
    v_permlane16_swap_b32 v116, v118
    v_mfma_f32_16x16x32_bf16 v[32:35], a[96:99], v[80:83], v[32:35]
    v_permlane16_swap_b32 v117, v119
    buffer_load_dwordx4 v147, s[28:31], s50 offen offset:2048 lds
    v_mfma_f32_16x16x32_bf16 v[48:51], a[160:163], v[80:83], v[48:51]
    v_add_f32 v116, v116, v118
    s_add_u32 s50, s50, 15360
    v_mfma_f32_16x16x32_bf16 v[64:67], a[224:227], v[80:83], v[64:67]
    v_add_f32 v117, v117, v119
    s_waitcnt lgkmcnt(0)
    v_mfma_f32_16x16x32_bf16 v[20:23], a[100:103], v[84:87], v[20:23]
    ds_read_b128 v[68:71], v8 offset:40960
    buffer_load_dwordx4 v147, s[28:31], s50 offen offset:3072 lds
    v_mfma_f32_16x16x32_bf16 v[36:39], a[164:167], v[84:87], v[36:39]
    ds_read_b128 v[72:75], v8 offset:41216
    s_mov_b32 s50, s64
    v_mfma_f32_16x16x32_bf16 v[52:55], a[228:231], v[84:87], v[52:55]
    ds_read_b128 v[76:79], v8 offset:41984
    s_mov_b32 s51, s65
    v_mfma_f32_16x16x32_bf16 v[24:27], a[100:103], v[88:91], v[24:27]
    ds_read_b128 v[80:83], v8 offset:42240
    s_add_u32 s50, s50, 393216
    v_mfma_f32_16x16x32_bf16 v[40:43], a[164:167], v[88:91], v[40:43]
    v_mov_b32 v118, v116
    s_add_u32 m0, s51, 21504
    v_mfma_f32_16x16x32_bf16 v[56:59], a[228:231], v[88:91], v[56:59]
    v_mov_b32 v119, v117
    buffer_load_dwordx4 v147, s[28:31], s50 offen offset:0 lds
    v_mfma_f32_16x16x32_bf16 v[28:31], a[100:103], v[92:95], v[28:31]
    v_permlane32_swap_b32 v116, v118
    s_add_u32 s50, s50, 15360
    v_mfma_f32_16x16x32_bf16 v[44:47], a[164:167], v[92:95], v[44:47]
    v_permlane32_swap_b32 v117, v119
    v_mfma_f32_16x16x32_bf16 v[60:63], a[228:231], v[92:95], v[60:63]
    v_add_f32 v116, v116, v118
    buffer_load_dwordx4 v147, s[28:31], s50 offen offset:1024 lds
    v_mfma_f32_16x16x32_bf16 v[32:35], a[100:103], v[96:99], v[32:35]
    v_add_f32 v117, v117, v119
    s_add_u32 s50, s50, 15360
    v_mfma_f32_16x16x32_bf16 v[48:51], a[164:167], v[96:99], v[48:51]
    v_mul_f32 v120, s54, v116
    v_mfma_f32_16x16x32_bf16 v[64:67], a[228:231], v[96:99], v[64:67]
    v_mul_f32 v118, v120, v120
    s_waitcnt lgkmcnt(0)
    buffer_load_dwordx4 v147, s[28:31], s50 offen offset:2048 lds
    v_mfma_f32_16x16x32_bf16 v[20:23], a[104:107], v[68:71], v[20:23]
    ds_read_b128 v[84:87], v8 offset:45056
    s_waitcnt vmcnt(11)
    v_mfma_f32_16x16x32_bf16 v[36:39], a[168:171], v[68:71], v[36:39]
    ds_read_b128 v[88:91], v8 offset:45312
    ds_read_b64_tr_b16 v[164:165], v146 offset:0
    v_mfma_f32_16x16x32_bf16 v[52:55], a[232:235], v[68:71], v[52:55]
    ds_read_b128 v[92:95], v8 offset:46080
    ds_read_b64_tr_b16 v[166:167], v146 offset:256
    v_mfma_f32_16x16x32_bf16 v[24:27], a[104:107], v[72:75], v[24:27]
    ds_read_b128 v[96:99], v8 offset:46336
    ds_read_b64_tr_b16 v[168:169], v146 offset:1024
    v_mfma_f32_16x16x32_bf16 v[40:43], a[168:171], v[72:75], v[40:43]
    v_fma_f32 v117, v117, s54, -v118
    ds_read_b64_tr_b16 v[170:171], v146 offset:1280
    v_mfma_f32_16x16x32_bf16 v[56:59], a[232:235], v[72:75], v[56:59]
    v_max_f32 v117, 0, v117
    ds_read_b64_tr_b16 v[172:173], v146 offset:2048
    v_mfma_f32_16x16x32_bf16 v[28:31], a[104:107], v[76:79], v[28:31]
    v_add_f32 v117, 0x3727c5ac, v117
    ds_read_b64_tr_b16 v[174:175], v146 offset:2304
    v_mfma_f32_16x16x32_bf16 v[44:47], a[168:171], v[76:79], v[44:47]
    v_rsq_f32 v118, v117
    v_mfma_f32_16x16x32_bf16 v[60:63], a[232:235], v[76:79], v[60:63]
    v_sub_f32 v120, 0, v120
    ds_read_b64_tr_b16 v[176:177], v146 offset:3072
    v_mfma_f32_16x16x32_bf16 v[32:35], a[104:107], v[80:83], v[32:35]
    v_mul_f32 v123, v117, v118
    ds_read_b64_tr_b16 v[178:179], v146 offset:3328
    v_mfma_f32_16x16x32_bf16 v[48:51], a[168:171], v[80:83], v[48:51]
    v_mul_f32 v121, s46, v118
    ds_read_b64_tr_b16 v[180:181], v146 offset:4096
    v_mfma_f32_16x16x32_bf16 v[64:67], a[232:235], v[80:83], v[64:67]
    v_mul_f32 v122, v118, v118
    s_waitcnt lgkmcnt(7)
    ds_read_b64_tr_b16 v[182:183], v146 offset:4352
    v_mfma_f32_16x16x32_bf16 v[20:23], a[108:111], v[84:87], v[20:23]
    ds_read_b64_tr_b16 v[184:185], v146 offset:5120
    ds_read_b64_tr_b16 v[186:187], v146 offset:5376
    v_mfma_f32_16x16x32_bf16 v[36:39], a[172:175], v[84:87], v[36:39]
    ds_read_b64_tr_b16 v[188:189], v146 offset:6144
    ds_read_b64_tr_b16 v[190:191], v146 offset:6400
    v_mfma_f32_16x16x32_bf16 v[52:55], a[236:239], v[84:87], v[52:55]
    ds_read_b64_tr_b16 a[0:1], v146 offset:7168
    ds_read_b64_tr_b16 a[2:3], v146 offset:7424
    v_mfma_f32_16x16x32_bf16 v[24:27], a[108:111], v[88:91], v[24:27]
    s_barrier
    buffer_store_dword v19, v0, s[36:39], s78 offen offset:512
    buffer_store_dword v19, v0, s[36:39], s79 offen offset:512 sc1
    v_mfma_f32_16x16x32_bf16 v[40:43], a[172:175], v[88:91], v[40:43]
    ds_read_b128 v[68:71], v8 offset:49152
    ds_read_b64_tr_b16 a[4:5], v146 offset:8192
    v_mfma_f32_16x16x32_bf16 v[56:59], a[236:239], v[88:91], v[56:59]
    ds_read_b128 v[72:75], v8 offset:49408
    ds_read_b64_tr_b16 a[6:7], v146 offset:8448
    v_mfma_f32_16x16x32_bf16 v[28:31], a[108:111], v[92:95], v[28:31]
    ds_read_b128 v[76:79], v8 offset:50176
    ds_read_b64_tr_b16 a[8:9], v146 offset:9216
    v_mfma_f32_16x16x32_bf16 v[44:47], a[172:175], v[92:95], v[44:47]
    ds_read_b128 v[80:83], v8 offset:50432
    ds_read_b64_tr_b16 a[10:11], v146 offset:9472
    v_mfma_f32_16x16x32_bf16 v[60:63], a[236:239], v[92:95], v[60:63]
    v_mul_f32 v122, v122, v118
    ds_read_b64_tr_b16 a[12:13], v146 offset:10240
    v_mfma_f32_16x16x32_bf16 v[32:35], a[108:111], v[96:99], v[32:35]
    v_mul_f32 v122, s47, v122
    ds_read_b64_tr_b16 a[14:15], v146 offset:10496
    v_mfma_f32_16x16x32_bf16 v[48:51], a[172:175], v[96:99], v[48:51]
    ds_write_b128 v9, v[120:123]
    ds_read_b64_tr_b16 a[16:17], v146 offset:11264
    v_mfma_f32_16x16x32_bf16 v[64:67], a[236:239], v[96:99], v[64:67]
    s_waitcnt lgkmcnt(5)
    ds_read_b64_tr_b16 a[18:19], v146 offset:11520
    s_mov_b32 s50, s64
    v_mfma_f32_16x16x32_bf16 v[20:23], a[112:115], v[68:71], v[20:23]
    ds_read_b128 v[84:87], v8 offset:53248
    s_mov_b32 s51, s65
    v_mfma_f32_16x16x32_bf16 v[36:39], a[176:179], v[68:71], v[36:39]
    ds_read_b128 v[88:91], v8 offset:53504
    s_add_u32 s50, s50, 442368
    v_mfma_f32_16x16x32_bf16 v[52:55], a[240:243], v[68:71], v[52:55]
    ds_read_b128 v[92:95], v8 offset:54272
    s_add_u32 m0, s51, 0
    v_mfma_f32_16x16x32_bf16 v[24:27], a[112:115], v[72:75], v[24:27]
    ds_read_b128 v[96:99], v8 offset:54528
    buffer_load_dwordx4 v147, s[28:31], s50 offen offset:0 lds
    v_mfma_f32_16x16x32_bf16 v[40:43], a[176:179], v[72:75], v[40:43]
    s_add_u32 s50, s50, 15360
    v_mfma_f32_16x16x32_bf16 v[56:59], a[240:243], v[72:75], v[56:59]
    v_mfma_f32_16x16x32_bf16 v[28:31], a[112:115], v[76:79], v[28:31]
    buffer_load_dwordx4 v147, s[28:31], s50 offen offset:1024 lds
    s_add_u32 s50, s50, 15360
    v_mfma_f32_16x16x32_bf16 v[44:47], a[176:179], v[76:79], v[44:47]
    v_mfma_f32_16x16x32_bf16 v[60:63], a[240:243], v[76:79], v[60:63]
    v_mfma_f32_16x16x32_bf16 v[32:35], a[112:115], v[80:83], v[32:35]
    buffer_load_dwordx4 v147, s[28:31], s50 offen offset:2048 lds
    s_add_u32 s50, s50, 15360
    v_mfma_f32_16x16x32_bf16 v[48:51], a[176:179], v[80:83], v[48:51]
    v_mfma_f32_16x16x32_bf16 v[64:67], a[240:243], v[80:83], v[64:67]
    s_waitcnt lgkmcnt(0)
    v_mfma_f32_16x16x32_bf16 v[20:23], a[116:119], v[84:87], v[20:23]
    ds_read_b128 v[68:71], v8 offset:57344
    buffer_load_dwordx4 v147, s[28:31], s50 offen offset:3072 lds
    v_mfma_f32_16x16x32_bf16 v[36:39], a[180:183], v[84:87], v[36:39]
    ds_read_b128 v[72:75], v8 offset:57600
    s_add_u32 m0, s51, 4096
    v_mfma_f32_16x16x32_bf16 v[52:55], a[244:247], v[84:87], v[52:55]
    ds_read_b128 v[76:79], v8 offset:58368
    s_add_u32 s50, s50, 19456
    v_mfma_f32_16x16x32_bf16 v[24:27], a[116:119], v[88:91], v[24:27]
    ds_read_b128 v[80:83], v8 offset:58624
    buffer_load_dwordx4 v147, s[28:31], s50 offen offset:0 lds
    v_mfma_f32_16x16x32_bf16 v[40:43], a[180:183], v[88:91], v[40:43]
    s_add_u32 s50, s50, 15360
    v_mfma_f32_16x16x32_bf16 v[56:59], a[244:247], v[88:91], v[56:59]
    v_mfma_f32_16x16x32_bf16 v[28:31], a[116:119], v[92:95], v[28:31]
    buffer_load_dwordx4 v147, s[28:31], s50 offen offset:1024 lds
    s_add_u32 s50, s50, 15360
    v_mfma_f32_16x16x32_bf16 v[44:47], a[180:183], v[92:95], v[44:47]
    v_mfma_f32_16x16x32_bf16 v[60:63], a[244:247], v[92:95], v[60:63]
    v_mfma_f32_16x16x32_bf16 v[32:35], a[116:119], v[96:99], v[32:35]
    buffer_load_dwordx4 v147, s[28:31], s50 offen offset:2048 lds
    s_add_u32 s50, s50, 15360
    v_mfma_f32_16x16x32_bf16 v[48:51], a[180:183], v[96:99], v[48:51]
    v_mfma_f32_16x16x32_bf16 v[64:67], a[244:247], v[96:99], v[64:67]
    s_waitcnt lgkmcnt(0)
    v_mfma_f32_16x16x32_bf16 v[20:23], a[120:123], v[68:71], v[20:23]
    ds_read_b128 v[84:87], v8 offset:61440
    buffer_load_dwordx4 v147, s[28:31], s50 offen offset:3072 lds
    v_mfma_f32_16x16x32_bf16 v[36:39], a[184:187], v[68:71], v[36:39]
    ds_read_b128 v[88:91], v8 offset:61696
    s_waitcnt vmcnt(13)
    v_mfma_f32_16x16x32_bf16 v[52:55], a[248:251], v[68:71], v[52:55]
    ds_read_b128 v[92:95], v8 offset:62464
    ds_read_b64_tr_b16 a[20:21], v146 offset:12288
    v_mfma_f32_16x16x32_bf16 v[24:27], a[120:123], v[72:75], v[24:27]
    ds_read_b128 v[96:99], v8 offset:62720
    ds_read_b64_tr_b16 a[22:23], v146 offset:12544
    v_mfma_f32_16x16x32_bf16 v[40:43], a[184:187], v[72:75], v[40:43]
    ds_read_b64_tr_b16 a[24:25], v146 offset:13312
    ds_read_b64_tr_b16 a[26:27], v146 offset:13568
    v_mfma_f32_16x16x32_bf16 v[56:59], a[248:251], v[72:75], v[56:59]
    ds_read_b64_tr_b16 a[28:29], v146 offset:14336
    ds_read_b64_tr_b16 a[30:31], v146 offset:14592
    v_mfma_f32_16x16x32_bf16 v[28:31], a[120:123], v[76:79], v[28:31]
    ds_read_b64_tr_b16 a[32:33], v146 offset:15360
    ds_read_b64_tr_b16 a[34:35], v146 offset:15616
    v_mfma_f32_16x16x32_bf16 v[44:47], a[184:187], v[76:79], v[44:47]
    ds_read_b64_tr_b16 a[36:37], v146 offset:16384
    ds_read_b64_tr_b16 a[38:39], v146 offset:16640
    v_mfma_f32_16x16x32_bf16 v[60:63], a[248:251], v[76:79], v[60:63]
    ds_read_b64_tr_b16 a[40:41], v146 offset:17408
    ds_read_b64_tr_b16 a[42:43], v146 offset:17664
    v_mfma_f32_16x16x32_bf16 v[32:35], a[120:123], v[80:83], v[32:35]
    ds_read_b64_tr_b16 a[44:45], v146 offset:18432
    ds_read_b64_tr_b16 a[46:47], v146 offset:18688
    v_mfma_f32_16x16x32_bf16 v[48:51], a[184:187], v[80:83], v[48:51]
    ds_read_b64_tr_b16 a[48:49], v146 offset:19456
    ds_read_b64_tr_b16 a[50:51], v146 offset:19712
    v_mfma_f32_16x16x32_bf16 v[64:67], a[248:251], v[80:83], v[64:67]
    s_waitcnt lgkmcnt(14)
    s_waitcnt lgkmcnt(8)
    s_mov_b32 s50, s64
    v_mfma_f32_16x16x32_bf16 v[20:23], a[124:127], v[84:87], v[20:23]
    s_mov_b32 s51, s65
    s_add_u32 s50, s50, 573440
    v_mfma_f32_16x16x32_bf16 v[36:39], a[188:191], v[84:87], v[36:39]
    s_add_u32 m0, s51, 8192
    s_nop 0
    buffer_load_dwordx4 v147, s[28:31], s50 offen offset:0 lds
    v_mfma_f32_16x16x32_bf16 v[52:55], a[252:255], v[84:87], v[52:55]
    s_add_u32 s50, s50, 15360
    v_mfma_f32_16x16x32_bf16 v[24:27], a[124:127], v[88:91], v[24:27]
    s_waitcnt lgkmcnt(0)
    s_barrier
    v_mfma_f32_16x16x32_bf16 v[40:43], a[188:191], v[88:91], v[40:43]
    ds_read_b128 v[116:119], v11 offset:0
    buffer_load_dwordx4 v147, s[28:31], s50 offen offset:1024 lds
    v_mfma_f32_16x16x32_bf16 v[56:59], a[252:255], v[88:91], v[56:59]
    ds_read_b128 v[120:123], v11 offset:256
    s_add_u32 s50, s50, 15360
    v_mfma_f32_16x16x32_bf16 v[28:31], a[124:127], v[92:95], v[28:31]
    ds_read_b128 v[124:127], v11 offset:512
    v_mfma_f32_16x16x32_bf16 v[44:47], a[188:191], v[92:95], v[44:47]
    ds_read_b128 v[128:131], v11 offset:768
    buffer_load_dwordx4 v147, s[28:31], s50 offen offset:2048 lds
    v_mfma_f32_16x16x32_bf16 v[60:63], a[252:255], v[92:95], v[60:63]
    s_add_u32 s50, s50, 15360
    v_mfma_f32_16x16x32_bf16 v[32:35], a[124:127], v[96:99], v[32:35]
    v_mfma_f32_16x16x32_bf16 v[48:51], a[188:191], v[96:99], v[48:51]
    buffer_load_dwordx4 v147, s[28:31], s50 offen offset:3072 lds
    s_add_u32 m0, s51, 12288
    v_mfma_f32_16x16x32_bf16 v[64:67], a[252:255], v[96:99], v[64:67]
    buffer_load_dword v14, v3, s[36:39], s66 offen offset:512 sc1
    s_waitcnt lgkmcnt(3)
    v_pk_fma_f32 v[20:21], v[132:133], v[116:117], v[20:21] op_sel_hi:[1,0,1]
    v_pk_fma_f32 v[22:23], v[134:135], v[116:117], v[22:23] op_sel_hi:[1,0,1]
    s_waitcnt lgkmcnt(2)
    v_pk_fma_f32 v[24:25], v[132:133], v[120:121], v[24:25] op_sel_hi:[1,0,1]
    v_pk_fma_f32 v[26:27], v[134:135], v[120:121], v[26:27] op_sel_hi:[1,0,1]
    s_add_u32 s50, s50, 19456
    s_waitcnt lgkmcnt(1)
    v_pk_fma_f32 v[28:29], v[132:133], v[124:125], v[28:29] op_sel_hi:[1,0,1]
    v_pk_fma_f32 v[30:31], v[134:135], v[124:125], v[30:31] op_sel_hi:[1,0,1]
    s_waitcnt lgkmcnt(0)
    v_pk_fma_f32 v[32:33], v[132:133], v[128:129], v[32:33] op_sel_hi:[1,0,1]
    v_pk_fma_f32 v[34:35], v[134:135], v[128:129], v[34:35] op_sel_hi:[1,0,1]
    v_pk_mul_f32 v[68:69], v[20:21], v[20:21]
    v_pk_mul_f32 v[70:71], v[22:23], v[22:23]
    v_pk_mul_f32 v[72:73], v[24:25], v[24:25]
    v_pk_mul_f32 v[74:75], v[26:27], v[26:27]
    buffer_load_dwordx4 v147, s[28:31], s50 offen offset:0 lds
    v_pk_mul_f32 v[76:77], v[28:29], v[28:29]
    v_pk_mul_f32 v[78:79], v[30:31], v[30:31]
    v_pk_mul_f32 v[80:81], v[32:33], v[32:33]
    v_pk_mul_f32 v[82:83], v[34:35], v[34:35]
    s_add_u32 s50, s50, 15360
    s_nop 0
    v_pk_fma_f32 v[68:69], v[68:69], v[118:119], v[116:117] op_sel:[0,0,1] op_sel_hi:[1,0,1]
    v_pk_fma_f32 v[70:71], v[70:71], v[118:119], v[116:117] op_sel:[0,0,1] op_sel_hi:[1,0,1]
    v_pk_fma_f32 v[72:73], v[72:73], v[122:123], v[120:121] op_sel:[0,0,1] op_sel_hi:[1,0,1]
    v_pk_fma_f32 v[74:75], v[74:75], v[122:123], v[120:121] op_sel:[0,0,1] op_sel_hi:[1,0,1]
    v_pk_fma_f32 v[76:77], v[76:77], v[126:127], v[124:125] op_sel:[0,0,1] op_sel_hi:[1,0,1]
    v_pk_fma_f32 v[78:79], v[78:79], v[126:127], v[124:125] op_sel:[0,0,1] op_sel_hi:[1,0,1]
    v_pk_fma_f32 v[80:81], v[80:81], v[130:131], v[128:129] op_sel:[0,0,1] op_sel_hi:[1,0,1]
    v_pk_fma_f32 v[82:83], v[82:83], v[130:131], v[128:129] op_sel:[0,0,1] op_sel_hi:[1,0,1]
    buffer_load_dwordx4 v147, s[28:31], s50 offen offset:1024 lds
    v_pk_mul_f32 v[68:69], v[68:69], v[20:21]
    v_pk_mul_f32 v[70:71], v[70:71], v[22:23]
    v_pk_mul_f32 v[72:73], v[72:73], v[24:25]
    v_pk_mul_f32 v[74:75], v[74:75], v[26:27]
    s_add_u32 s50, s50, 15360
    v_pk_mul_f32 v[76:77], v[76:77], v[28:29]
    v_pk_mul_f32 v[78:79], v[78:79], v[30:31]
    v_pk_mul_f32 v[80:81], v[80:81], v[32:33]
    v_pk_mul_f32 v[82:83], v[82:83], v[34:35]
    v_exp_f32 v68, v68
    v_exp_f32 v70, v70
    v_exp_f32 v72, v72
    v_exp_f32 v74, v74
    buffer_load_dwordx4 v147, s[28:31], s50 offen offset:2048 lds
    v_exp_f32 v76, v76
    v_exp_f32 v78, v78
    v_exp_f32 v80, v80
    v_exp_f32 v82, v82
    s_add_u32 s50, s50, 15360
    v_exp_f32 v69, v69
    v_exp_f32 v71, v71
    v_exp_f32 v73, v73
    v_exp_f32 v75, v75
    buffer_load_dwordx4 v147, s[28:31], s50 offen offset:3072 lds
    v_exp_f32 v77, v77
    v_exp_f32 v79, v79
    v_exp_f32 v81, v81
    v_exp_f32 v83, v83
    v_pk_fma_f32 v[68:69], v[68:69], v[118:119], v[118:119] op_sel:[0,1,1] op_sel_hi:[1,1,1]
    v_pk_fma_f32 v[70:71], v[70:71], v[118:119], v[118:119] op_sel:[0,1,1] op_sel_hi:[1,1,1]
    v_pk_fma_f32 v[72:73], v[72:73], v[122:123], v[122:123] op_sel:[0,1,1] op_sel_hi:[1,1,1]
    v_pk_fma_f32 v[74:75], v[74:75], v[122:123], v[122:123] op_sel:[0,1,1] op_sel_hi:[1,1,1]
    v_pk_fma_f32 v[76:77], v[76:77], v[126:127], v[126:127] op_sel:[0,1,1] op_sel_hi:[1,1,1]
    v_pk_fma_f32 v[78:79], v[78:79], v[126:127], v[126:127] op_sel:[0,1,1] op_sel_hi:[1,1,1]
    v_pk_fma_f32 v[80:81], v[80:81], v[130:131], v[130:131] op_sel:[0,1,1] op_sel_hi:[1,1,1]
    v_pk_fma_f32 v[82:83], v[82:83], v[130:131], v[130:131] op_sel:[0,1,1] op_sel_hi:[1,1,1]
    v_rcp_f32 v68, v68
    v_rcp_f32 v70, v70
    v_rcp_f32 v72, v72
    v_rcp_f32 v74, v74
    v_rcp_f32 v76, v76
    v_rcp_f32 v78, v78
    v_rcp_f32 v80, v80
    v_rcp_f32 v82, v82
    v_rcp_f32 v69, v69
    v_rcp_f32 v71, v71
    v_rcp_f32 v73, v73
    v_rcp_f32 v75, v75
    v_rcp_f32 v77, v77
    v_rcp_f32 v79, v79
    v_rcp_f32 v81, v81
    v_rcp_f32 v83, v83
    v_pk_mul_f32 v[68:69], v[68:69], v[20:21]
    v_pk_mul_f32 v[70:71], v[70:71], v[22:23]
    v_pk_mul_f32 v[72:73], v[72:73], v[24:25]
    v_pk_mul_f32 v[74:75], v[74:75], v[26:27]
    v_pk_mul_f32 v[76:77], v[76:77], v[28:29]
    v_pk_mul_f32 v[78:79], v[78:79], v[30:31]
    v_pk_mul_f32 v[80:81], v[80:81], v[32:33]
    v_pk_mul_f32 v[82:83], v[82:83], v[34:35]
    v_cvt_pk_bf16_f32 v84, v68, v69
    v_cvt_pk_bf16_f32 v85, v70, v71
    v_cvt_pk_bf16_f32 v86, v72, v73
    v_cvt_pk_bf16_f32 v87, v74, v75
    v_cvt_pk_bf16_f32 v88, v76, v77
    v_cvt_pk_bf16_f32 v89, v78, v79
    v_cvt_pk_bf16_f32 v90, v80, v81
    v_cvt_pk_bf16_f32 v91, v82, v83
    v_permlane16_swap_b32 v84, v86
    v_permlane16_swap_b32 v85, v87
    v_permlane16_swap_b32 v88, v90
    v_permlane16_swap_b32 v89, v91
    s_waitcnt vmcnt(4)
    v_cmp_ne_u32 vcc, s67, v14
    s_nop 0
    s_cbranch_vccnz COLD_29
COLDE_30:
    s_cmp_lt_u32 s60, 135168
    s_cselect_b32 s56, s44, 0
    s_cmp_eq_u32 s56, 1
    s_cselect_b32 s56, s60, 0x40000000
    s_cselect_b32 s60, 0x40000000, s60
    buffer_store_dwordx4 v[84:87], v2, s[24:27], s56 offen offset:0
    buffer_store_dwordx4 v[88:91], v2, s[24:27], s56 offen offset:1024
    buffer_store_dwordx4 v[84:87], v2, s[24:27], s60 offen offset:0 sc1
    buffer_store_dwordx4 v[88:91], v2, s[24:27], s60 offen offset:1024 sc1
    v_pk_fma_f32 v[36:37], v[136:137], v[116:117], v[36:37] op_sel_hi:[1,0,1]
    v_pk_fma_f32 v[38:39], v[138:139], v[116:117], v[38:39] op_sel_hi:[1,0,1]
    v_pk_fma_f32 v[40:41], v[136:137], v[120:121], v[40:41] op_sel_hi:[1,0,1]
    v_pk_fma_f32 v[42:43], v[138:139], v[120:121], v[42:43] op_sel_hi:[1,0,1]
    v_pk_fma_f32 v[44:45], v[136:137], v[124:125], v[44:45] op_sel_hi:[1,0,1]
    v_pk_fma_f32 v[46:47], v[138:139], v[124:125], v[46:47] op_sel_hi:[1,0,1]
    v_pk_fma_f32 v[48:49], v[136:137], v[128:129], v[48:49] op_sel_hi:[1,0,1]
    v_pk_fma_f32 v[50:51], v[138:139], v[128:129], v[50:51] op_sel_hi:[1,0,1]
    v_pk_mul_f32 v[68:69], v[36:37], v[36:37]
    v_pk_mul_f32 v[70:71], v[38:39], v[38:39]
    v_pk_mul_f32 v[72:73], v[40:41], v[40:41]
    v_pk_mul_f32 v[74:75], v[42:43], v[42:43]
    v_pk_mul_f32 v[76:77], v[44:45], v[44:45]
    v_pk_mul_f32 v[78:79], v[46:47], v[46:47]
    v_pk_mul_f32 v[80:81], v[48:49], v[48:49]
    v_pk_mul_f32 v[82:83], v[50:51], v[50:51]
    v_pk_fma_f32 v[68:69], v[68:69], v[118:119], v[116:117] op_sel:[0,0,1] op_sel_hi:[1,0,1]
    v_pk_fma_f32 v[70:71], v[70:71], v[118:119], v[116:117] op_sel:[0,0,1] op_sel_hi:[1,0,1]
    v_pk_fma_f32 v[72:73], v[72:73], v[122:123], v[120:121] op_sel:[0,0,1] op_sel_hi:[1,0,1]
    v_pk_fma_f32 v[74:75], v[74:75], v[122:123], v[120:121] op_sel:[0,0,1] op_sel_hi:[1,0,1]
    v_pk_fma_f32 v[76:77], v[76:77], v[126:127], v[124:125] op_sel:[0,0,1] op_sel_hi:[1,0,1]
    v_pk_fma_f32 v[78:79], v[78:79], v[126:127], v[124:125] op_sel:[0,0,1] op_sel_hi:[1,0,1]
    v_pk_fma_f32 v[80:81], v[80:81], v[130:131], v[128:129] op_sel:[0,0,1] op_sel_hi:[1,0,1]
    v_pk_fma_f32 v[82:83], v[82:83], v[130:131], v[128:129] op_sel:[0,0,1] op_sel_hi:[1,0,1]
    v_pk_mul_f32 v[68:69], v[68:69], v[36:37]
    v_pk_mul_f32 v[70:71], v[70:71], v[38:39]
    v_pk_mul_f32 v[72:73], v[72:73], v[40:41]
    v_pk_mul_f32 v[74:75], v[74:75], v[42:43]
    v_pk_mul_f32 v[76:77], v[76:77], v[44:45]
    v_pk_mul_f32 v[78:79], v[78:79], v[46:47]
    v_pk_mul_f32 v[80:81], v[80:81], v[48:49]
    v_pk_mul_f32 v[82:83], v[82:83], v[50:51]
    v_exp_f32 v68, v68
    v_exp_f32 v70, v70
    v_exp_f32 v72, v72
    v_exp_f32 v74, v74
    v_exp_f32 v76, v76
    v_exp_f32 v78, v78
    v_exp_f32 v80, v80
    v_exp_f32 v82, v82
    v_exp_f32 v69, v69
    v_exp_f32 v71, v71
    v_exp_f32 v73, v73
    v_exp_f32 v75, v75
    v_exp_f32 v77, v77
    v_exp_f32 v79, v79
    v_exp_f32 v81, v81
    v_exp_f32 v83, v83
    v_pk_fma_f32 v[68:69], v[68:69], v[118:119], v[118:119] op_sel:[0,1,1] op_sel_hi:[1,1,1]
    v_pk_fma_f32 v[70:71], v[70:71], v[118:119], v[118:119] op_sel:[0,1,1] op_sel_hi:[1,1,1]
    v_pk_fma_f32 v[72:73], v[72:73], v[122:123], v[122:123] op_sel:[0,1,1] op_sel_hi:[1,1,1]
    v_pk_fma_f32 v[74:75], v[74:75], v[122:123], v[122:123] op_sel:[0,1,1] op_sel_hi:[1,1,1]
    v_pk_fma_f32 v[76:77], v[76:77], v[126:127], v[126:127] op_sel:[0,1,1] op_sel_hi:[1,1,1]
    v_pk_fma_f32 v[78:79], v[78:79], v[126:127], v[126:127] op_sel:[0,1,1] op_sel_hi:[1,1,1]
    v_pk_fma_f32 v[80:81], v[80:81], v[130:131], v[130:131] op_sel:[0,1,1] op_sel_hi:[1,1,1]
    v_pk_fma_f32 v[82:83], v[82:83], v[130:131], v[130:131] op_sel:[0,1,1] op_sel_hi:[1,1,1]
    v_rcp_f32 v68, v68
    v_rcp_f32 v70, v70
    v_rcp_f32 v72, v72
    v_rcp_f32 v74, v74
    v_rcp_f32 v76, v76
    v_rcp_f32 v78, v78
    v_rcp_f32 v80, v80
    v_rcp_f32 v82, v82
    v_rcp_f32 v69, v69
    v_rcp_f32 v71, v71
    v_rcp_f32 v73, v73
    v_rcp_f32 v75, v75
    v_rcp_f32 v77, v77
    v_rcp_f32 v79, v79
    v_rcp_f32 v81, v81
    v_rcp_f32 v83, v83
    v_pk_mul_f32 v[68:69], v[68:69], v[36:37]
    v_pk_mul_f32 v[70:71], v[70:71], v[38:39]
    v_pk_mul_f32 v[72:73], v[72:73], v[40:41]
    v_pk_mul_f32 v[74:75], v[74:75], v[42:43]
    v_pk_mul_f32 v[76:77], v[76:77], v[44:45]
    v_pk_mul_f32 v[78:79], v[78:79], v[46:47]
    v_pk_mul_f32 v[80:81], v[80:81], v[48:49]
    v_pk_mul_f32 v[82:83], v[82:83], v[50:51]
    v_cvt_pk_bf16_f32 v92, v68, v69
    v_cvt_pk_bf16_f32 v93, v70, v71
    v_cvt_pk_bf16_f32 v94, v72, v73
    v_cvt_pk_bf16_f32 v95, v74, v75
    v_cvt_pk_bf16_f32 v96, v76, v77
    v_cvt_pk_bf16_f32 v97, v78, v79
    v_cvt_pk_bf16_f32 v98, v80, v81
    v_cvt_pk_bf16_f32 v99, v82, v83
    v_permlane16_swap_b32 v92, v94
    v_permlane16_swap_b32 v93, v95
    v_permlane16_swap_b32 v96, v98
    v_permlane16_swap_b32 v97, v99
    s_cmp_lt_u32 s61, 135168
    s_cselect_b32 s56, s44, 0
    s_cmp_eq_u32 s56, 1
    s_cselect_b32 s56, s61, 0x40000000
    s_cselect_b32 s61, 0x40000000, s61
    buffer_store_dwordx4 v[92:95], v2, s[24:27], s56 offen offset:0
    buffer_store_dwordx4 v[96:99], v2, s[24:27], s56 offen offset:1024
    buffer_store_dwordx4 v[92:95], v2, s[24:27], s61 offen offset:0 sc1
    buffer_store_dwordx4 v[96:99], v2, s[24:27], s61 offen offset:1024 sc1
    s_cmp_eq_u32 s62, 0x40000000
    s_cbranch_scc1 NOT3_33
    v_pk_fma_f32 v[52:53], v[140:141], v[116:117], v[52:53] op_sel_hi:[1,0,1]
    v_pk_fma_f32 v[54:55], v[142:143], v[116:117], v[54:55] op_sel_hi:[1,0,1]
    v_pk_fma_f32 v[56:57], v[140:141], v[120:121], v[56:57] op_sel_hi:[1,0,1]
    v_pk_fma_f32 v[58:59], v[142:143], v[120:121], v[58:59] op_sel_hi:[1,0,1]
    v_pk_fma_f32 v[60:61], v[140:141], v[124:125], v[60:61] op_sel_hi:[1,0,1]
    v_pk_fma_f32 v[62:63], v[142:143], v[124:125], v[62:63] op_sel_hi:[1,0,1]
    v_pk_fma_f32 v[64:65], v[140:141], v[128:129], v[64:65] op_sel_hi:[1,0,1]
    v_pk_fma_f32 v[66:67], v[142:143], v[128:129], v[66:67] op_sel_hi:[1,0,1]
    v_pk_mul_f32 v[68:69], v[52:53], v[52:53]
    v_pk_mul_f32 v[70:71], v[54:55], v[54:55]
    v_pk_mul_f32 v[72:73], v[56:57], v[56:57]
    v_pk_mul_f32 v[74:75], v[58:59], v[58:59]
    v_pk_mul_f32 v[76:77], v[60:61], v[60:61]
    v_pk_mul_f32 v[78:79], v[62:63], v[62:63]
    v_pk_mul_f32 v[80:81], v[64:65], v[64:65]
    v_pk_mul_f32 v[82:83], v[66:67], v[66:67]
    v_pk_fma_f32 v[68:69], v[68:69], v[118:119], v[116:117] op_sel:[0,0,1] op_sel_hi:[1,0,1]
    v_pk_fma_f32 v[70:71], v[70:71], v[118:119], v[116:117] op_sel:[0,0,1] op_sel_hi:[1,0,1]
    v_pk_fma_f32 v[72:73], v[72:73], v[122:123], v[120:121] op_sel:[0,0,1] op_sel_hi:[1,0,1]
    v_pk_fma_f32 v[74:75], v[74:75], v[122:123], v[120:121] op_sel:[0,0,1] op_sel_hi:[1,0,1]
    v_pk_fma_f32 v[76:77], v[76:77], v[126:127], v[124:125] op_sel:[0,0,1] op_sel_hi:[1,0,1]
    v_pk_fma_f32 v[78:79], v[78:79], v[126:127], v[124:125] op_sel:[0,0,1] op_sel_hi:[1,0,1]
    v_pk_fma_f32 v[80:81], v[80:81], v[130:131], v[128:129] op_sel:[0,0,1] op_sel_hi:[1,0,1]
    v_pk_fma_f32 v[82:83], v[82:83], v[130:131], v[128:129] op_sel:[0,0,1] op_sel_hi:[1,0,1]
    v_pk_mul_f32 v[68:69], v[68:69], v[52:53]
    v_pk_mul_f32 v[70:71], v[70:71], v[54:55]
    v_pk_mul_f32 v[72:73], v[72:73], v[56:57]
    v_pk_mul_f32 v[74:75], v[74:75], v[58:59]
    v_pk_mul_f32 v[76:77], v[76:77], v[60:61]
    v_pk_mul_f32 v[78:79], v[78:79], v[62:63]
    v_pk_mul_f32 v[80:81], v[80:81], v[64:65]
    v_pk_mul_f32 v[82:83], v[82:83], v[66:67]
    v_exp_f32 v68, v68
    v_exp_f32 v70, v70
    v_exp_f32 v72, v72
    v_exp_f32 v74, v74
    v_exp_f32 v76, v76
    v_exp_f32 v78, v78
    v_exp_f32 v80, v80
    v_exp_f32 v82, v82
    v_exp_f32 v69, v69
    v_exp_f32 v71, v71
    v_exp_f32 v73, v73
    v_exp_f32 v75, v75
    v_exp_f32 v77, v77
    v_exp_f32 v79, v79
    v_exp_f32 v81, v81
    v_exp_f32 v83, v83
    v_pk_fma_f32 v[68:69], v[68:69], v[118:119], v[118:119] op_sel:[0,1,1] op_sel_hi:[1,1,1]
    v_pk_fma_f32 v[70:71], v[70:71], v[118:119], v[118:119] op_sel:[0,1,1] op_sel_hi:[1,1,1]
    v_pk_fma_f32 v[72:73], v[72:73], v[122:123], v[122:123] op_sel:[0,1,1] op_sel_hi:[1,1,1]
    v_pk_fma_f32 v[74:75], v[74:75], v[122:123], v[122:123] op_sel:[0,1,1] op_sel_hi:[1,1,1]
    v_pk_fma_f32 v[76:77], v[76:77], v[126:127], v[126:127] op_sel:[0,1,1] op_sel_hi:[1,1,1]
    v_pk_fma_f32 v[78:79], v[78:79], v[126:127], v[126:127] op_sel:[0,1,1] op_sel_hi:[1,1,1]
    v_pk_fma_f32 v[80:81], v[80:81], v[130:131], v[130:131] op_sel:[0,1,1] op_sel_hi:[1,1,1]
    v_pk_fma_f32 v[82:83], v[82:83], v[130:131], v[130:131] op_sel:[0,1,1] op_sel_hi:[1,1,1]
    v_rcp_f32 v68, v68
    v_rcp_f32 v70, v70
    v_rcp_f32 v72, v72
    v_rcp_f32 v74, v74
    v_rcp_f32 v76, v76
    v_rcp_f32 v78, v78
    v_rcp_f32 v80, v80
    v_rcp_f32 v82, v82
    v_rcp_f32 v69, v69
    v_rcp_f32 v71, v71
    v_rcp_f32 v73, v73
    v_rcp_f32 v75, v75
    v_rcp_f32 v77, v77
    v_rcp_f32 v79, v79
    v_rcp_f32 v81, v81
    v_rcp_f32 v83, v83
    v_pk_mul_f32 v[68:69], v[68:69], v[52:53]
    v_pk_mul_f32 v[70:71], v[70:71], v[54:55]
    v_pk_mul_f32 v[72:73], v[72:73], v[56:57]
    v_pk_mul_f32 v[74:75], v[74:75], v[58:59]
    v_pk_mul_f32 v[76:77], v[76:77], v[60:61]
    v_pk_mul_f32 v[78:79], v[78:79], v[62:63]
    v_pk_mul_f32 v[80:81], v[80:81], v[64:65]
    v_pk_mul_f32 v[82:83], v[82:83], v[66:67]
    v_cvt_pk_bf16_f32 v84, v68, v69
    v_cvt_pk_bf16_f32 v85, v70, v71
    v_cvt_pk_bf16_f32 v86, v72, v73
    v_cvt_pk_bf16_f32 v87, v74, v75
    v_cvt_pk_bf16_f32 v88, v76, v77
    v_cvt_pk_bf16_f32 v89, v78, v79
    v_cvt_pk_bf16_f32 v90, v80, v81
    v_cvt_pk_bf16_f32 v91, v82, v83
    v_permlane16_swap_b32 v84, v86
    v_permlane16_swap_b32 v85, v87
    v_permlane16_swap_b32 v88, v90
    v_permlane16_swap_b32 v89, v91
    s_cmp_lt_u32 s62, 135168
    s_cselect_b32 s56, s44, 0
    s_cmp_eq_u32 s56, 1
    s_cselect_b32 s56, s62, 0x40000000
    s_cselect_b32 s62, 0x40000000, s62
    buffer_store_dwordx4 v[84:87], v2, s[24:27], s56 offen offset:0
    buffer_store_dwordx4 v[88:91], v2, s[24:27], s56 offen offset:1024
    buffer_store_dwordx4 v[84:87], v2, s[24:27], s62 offen offset:0 sc1
    buffer_store_dwordx4 v[88:91], v2, s[24:27], s62 offen offset:1024 sc1
NOT3_33:
    ds_read_b64_tr_b16 a[52:53], v146 offset:21504
    ds_read_b64_tr_b16 a[54:55], v146 offset:21760
    ds_read_b64_tr_b16 a[56:57], v146 offset:22528
    ds_read_b64_tr_b16 a[58:59], v146 offset:22784
    ds_read_b64_tr_b16 a[60:61], v146 offset:23552
    ds_read_b64_tr_b16 a[62:63], v146 offset:23808
    ds_read_b64_tr_b16 v[192:193], v146 offset:0
    ds_read_b64_tr_b16 v[194:195], v146 offset:256
    ds_read_b64_tr_b16 v[196:197], v146 offset:1024
    ds_read_b64_tr_b16 v[198:199], v146 offset:1280
    ds_read_b64_tr_b16 v[200:201], v146 offset:2048
    ds_read_b64_tr_b16 v[202:203], v146 offset:2304
    ds_read_b64_tr_b16 v[204:205], v146 offset:3072
    ds_read_b64_tr_b16 v[206:207], v146 offset:3328
    ds_read_b64_tr_b16 v[208:209], v146 offset:4096
    ds_read_b64_tr_b16 v[210:211], v146 offset:4352
    ds_read_b64_tr_b16 v[212:213], v146 offset:5120
    ds_read_b64_tr_b16 v[214:215], v146 offset:5376
    ds_read_b64_tr_b16 v[216:217], v146 offset:6144
    ds_read_b64_tr_b16 v[218:219], v146 offset:6400
    ds_read_b64_tr_b16 v[220:221], v146 offset:7168
    ds_read_b64_tr_b16 v[222:223], v146 offset:7424
    s_waitcnt vmcnt(8)
    ds_read_b64_tr_b16 v[224:225], v146 offset:8192
    ds_read_b64_tr_b16 v[226:227], v146 offset:8448
    ds_read_b64_tr_b16 v[228:229], v146 offset:9216
    ds_read_b64_tr_b16 v[230:231], v146 offset:9472
    ds_read_b64_tr_b16 v[232:233], v146 offset:10240
    ds_read_b64_tr_b16 v[234:235], v146 offset:10496
    ds_read_b64_tr_b16 v[236:237], v146 offset:11264
    ds_read_b64_tr_b16 v[238:239], v146 offset:11520
    ds_read_b64_tr_b16 v[240:241], v146 offset:12288
    ds_read_b64_tr_b16 v[242:243], v146 offset:12544
    ds_read_b64_tr_b16 v[244:245], v146 offset:13312
    ds_read_b64_tr_b16 v[246:247], v146 offset:13568
    ds_read_b64_tr_b16 v[248:249], v146 offset:14336
    ds_read_b64_tr_b16 v[250:251], v146 offset:14592
    ds_read_b64_tr_b16 v[252:253], v146 offset:15360
    ds_read_b64_tr_b16 v[254:255], v146 offset:15616
    s_mul_i32 s58, s6, 9216
    v_add_u32 v4, s58, v2
    v_xor_b32 v5, 1024, v4
    v_add_u32 v6, 65536, v4
    v_add_u32 v7, 65536, v5
    s_mul_i32 s58, s6, 88064
    s_lshl_b32 s57, s7, 12
    s_add_u32 s58, s58, s57
    s_lshl_b32 s55, s5, 12
    s_waitcnt vmcnt(0)
    s_waitcnt lgkmcnt(0)
    buffer_store_dword v19, v0, s[36:39], s78 offen offset:384
    buffer_store_dword v19, v0, s[36:39], s79 offen offset:384 sc1
    s_mov_b32 s49, 0
POLL_34:
    buffer_load_dword v14, v3, s[36:39], s66 offen offset:384 sc1
    s_add_u32 s49, s49, 1
    s_cmp_gt_u32 s49, 0x200000
    s_cbranch_scc1 POLLE_35
    s_waitcnt vmcnt(0)
    v_cmp_ne_u32 vcc, s67, v14
    s_nop 0
    s_cbranch_vccnz POLL_34
POLLE_35:
    s_waitcnt vmcnt(0)
    s_add_u32 m0, s55, 0
    s_nop 0
    buffer_load_dwordx4 v2, s[24:27], s58 offen offset:0 sc1 lds
    buffer_load_dwordx4 v2, s[24:27], s58 offen offset:1024 sc1 lds
    buffer_load_dwordx4 v2, s[24:27], s58 offen offset:2048 sc1 lds
    buffer_load_dwordx4 v2, s[24:27], s58 offen offset:3072 sc1 lds
    s_add_u32 s58, s58, 8192
    s_add_u32 m0, s55, 16384
    s_nop 0
    buffer_load_dwordx4 v2, s[24:27], s58 offen offset:0 sc1 lds
    buffer_load_dwordx4 v2, s[24:27], s58 offen offset:1024 sc1 lds
    buffer_load_dwordx4 v2, s[24:27], s58 offen offset:2048 sc1 lds
    buffer_load_dwordx4 v2, s[24:27], s58 offen offset:3072 sc1 lds
    s_add_u32 s58, s58, 8192
    s_add_u32 m0, s55, 32768
    s_nop 0
    buffer_load_dwordx4 v2, s[24:27], s58 offen offset:0 sc1 lds
    buffer_load_dwordx4 v2, s[24:27], s58 offen offset:1024 sc1 lds
    buffer_load_dwordx4 v2, s[24:27], s58 offen offset:2048 sc1 lds
    buffer_load_dwordx4 v2, s[24:27], s58 offen offset:3072 sc1 lds
    s_add_u32 s58, s58, 8192
    s_add_u32 m0, s55, 49152
    s_nop 0
    buffer_load_dwordx4 v2, s[24:27], s58 offen offset:0 sc1 lds
    buffer_load_dwordx4 v2, s[24:27], s58 offen offset:1024 sc1 lds
    buffer_load_dwordx4 v2, s[24:27], s58 offen offset:2048 sc1 lds
    buffer_load_dwordx4 v2, s[24:27], s58 offen offset:3072 sc1 lds
    s_waitcnt vmcnt(12)
    s_barrier
    ds_read_b128 v[72:75], v5 offset:0
    ds_read_b128 v[68:71], v4 offset:0
    ds_read_b128 v[80:83], v5 offset:2048
    ds_read_b128 v[76:79], v4 offset:2048
    ds_read_b128 v[88:91], v5 offset:4096
    ds_read_b128 v[84:87], v4 offset:4096
    s_waitcnt lgkmcnt(5)
    v_mfma_f32_32x32x16_bf16 v[36:51], v[148:151], v[72:75], 0
    ds_read_b128 v[96:99], v5 offset:6144
    ds_read_b128 v[92:95], v4 offset:6144
    s_add_u32 s58, s58, 8192
    s_add_u32 m0, s55, 65536
    s_nop 0
    buffer_load_dwordx4 v2, s[24:27], s58 offen offset:0 sc1 lds
    s_waitcnt lgkmcnt(6)
    v_mfma_f32_32x32x16_bf16 v[20:35], v[148:151], v[68:71], 0
    s_waitcnt lgkmcnt(5)
    v_mfma_f32_32x32x16_bf16 v[36:51], v[152:155], v[80:83], v[36:51]
    buffer_load_dwordx4 v2, s[24:27], s58 offen offset:1024 sc1 lds
    s_waitcnt lgkmcnt(4)
    v_mfma_f32_32x32x16_bf16 v[20:35], v[152:155], v[76:79], v[20:35]
    s_waitcnt lgkmcnt(3)
    v_mfma_f32_32x32x16_bf16 v[36:51], v[156:159], v[88:91], v[36:51]
    buffer_load_dwordx4 v2, s[24:27], s58 offen offset:2048 sc1 lds
    s_waitcnt lgkmcnt(2)
    v_mfma_f32_32x32x16_bf16 v[20:35], v[156:159], v[84:87], v[20:35]
    s_waitcnt vmcnt(11)
    s_barrier
    s_waitcnt lgkmcnt(1)
    v_mfma_f32_32x32x16_bf16 v[36:51], v[160:163], v[96:99], v[36:51]
    ds_read_b128 v[72:75], v5 offset:16384
    ds_read_b128 v[68:71], v4 offset:16384
    buffer_load_dwordx4 v2, s[24:27], s58 offen offset:3072 sc1 lds
    s_add_u32 s58, s58, 8192
    s_add_u32 m0, s55, 90112
    s_waitcnt lgkmcnt(2)
    v_mfma_f32_32x32x16_bf16 v[20:35], v[160:163], v[92:95], v[20:35]
    ds_read_b128 v[80:83], v5 offset:18432
    ds_read_b128 v[76:79], v4 offset:18432
    s_waitcnt lgkmcnt(3)
    v_mfma_f32_32x32x16_bf16 v[36:51], v[164:167], v[72:75], v[36:51]
    ds_read_b128 v[88:91], v5 offset:20480
    ds_read_b128 v[84:87], v4 offset:20480
    buffer_load_dwordx4 v2, s[24:27], s58 offen offset:0 sc1 lds
    s_waitcnt lgkmcnt(4)
    v_mfma_f32_32x32x16_bf16 v[20:35], v[164:167], v[68:71], v[20:35]
    ds_read_b128 v[96:99], v5 offset:22528
    ds_read_b128 v[92:95], v4 offset:22528
    s_waitcnt lgkmcnt(5)
    v_mfma_f32_32x32x16_bf16 v[36:51], v[168:171], v[80:83], v[36:51]
    buffer_load_dwordx4 v2, s[24:27], s58 offen offset:1024 sc1 lds
    s_waitcnt lgkmcnt(4)
    v_mfma_f32_32x32x16_bf16 v[20:35], v[168:171], v[76:79], v[20:35]
    s_waitcnt lgkmcnt(3)
    v_mfma_f32_32x32x16_bf16 v[36:51], v[172:175], v[88:91], v[36:51]
    buffer_load_dwordx4 v2, s[24:27], s58 offen offset:2048 sc1 lds
    s_waitcnt lgkmcnt(2)
    v_mfma_f32_32x32x16_bf16 v[20:35], v[172:175], v[84:87], v[20:35]
    s_waitcnt vmcnt(7)
    s_waitcnt lgkmcnt(0)
    s_barrier
    v_mfma_f32_32x32x16_bf16 v[36:51], v[176:179], v[96:99], v[36:51]
    ds_read_b128 v[72:75], v5 offset:32768
    ds_read_b128 v[68:71], v4 offset:32768
    buffer_load_dwordx4 v2, s[24:27], s58 offen offset:3072 sc1 lds
    s_add_u32 s58, s58, 8192
    s_add_u32 m0, s55, 114688
    v_mfma_f32_32x32x16_bf16 v[20:35], v[176:179], v[92:95], v[20:35]
    ds_read_b128 v[80:83], v5 offset:34816
    ds_read_b128 v[76:79], v4 offset:34816
    s_waitcnt lgkmcnt(3)
    v_mfma_f32_32x32x16_bf16 v[36:51], v[180:183], v[72:75], v[36:51]
    ds_read_b128 v[88:91], v5 offset:36864
    ds_read_b128 v[84:87], v4 offset:36864
    buffer_load_dwordx4 v2, s[24:27], s58 offen offset:0 sc1 lds
    s_waitcnt lgkmcnt(4)
    v_mfma_f32_32x32x16_bf16 v[20:35], v[180:183], v[68:71], v[20:35]
    ds_read_b128 v[96:99], v5 offset:38912
    ds_read_b128 v[92:95], v4 offset:38912
    s_waitcnt lgkmcnt(5)
    v_mfma_f32_32x32x16_bf16 v[36:51], v[184:187], v[80:83], v[36:51]
    ds_read_b128 v[72:75], v5 offset:49152
    ds_read_b128 v[68:71], v4 offset:49152
    buffer_load_dwordx4 v2, s[24:27], s58 offen offset:1024 sc1 lds
    s_waitcnt lgkmcnt(6)
    v_mfma_f32_32x32x16_bf16 v[20:35], v[184:187], v[76:79], v[20:35]
    s_waitcnt lgkmcnt(5)
    v_mfma_f32_32x32x16_bf16 v[36:51], v[188:191], v[88:91], v[36:51]
    ds_read_b128 v[80:83], v5 offset:51200
    ds_read_b128 v[76:79], v4 offset:51200
    buffer_load_dwordx4 v2, s[24:27], s58 offen offset:2048 sc1 lds
    s_waitcnt lgkmcnt(6)
    v_mfma_f32_32x32x16_bf16 v[20:35], v[188:191], v[84:87], v[20:35]
    s_waitcnt lgkmcnt(5)
    v_mfma_f32_32x32x16_bf16 v[36:51], a[0:3], v[96:99], v[36:51]
    ds_read_b128 v[88:91], v5 offset:53248
    ds_read_b128 v[84:87], v4 offset:53248
    buffer_load_dwordx4 v2, s[24:27], s58 offen offset:3072 sc1 lds
    s_add_u32 s58, s58, 8192
    s_add_u32 m0, s55, 0
    s_waitcnt lgkmcnt(6)
    v_mfma_f32_32x32x16_bf16 v[20:35], a[0:3], v[92:95], v[20:35]
    s_waitcnt lgkmcnt(5)
    v_mfma_f32_32x32x16_bf16 v[36:51], a[4:7], v[72:75], v[36:51]
    ds_read_b128 v[96:99], v5 offset:55296
    ds_read_b128 v[92:95], v4 offset:55296
    buffer_load_dwordx4 v2, s[24:27], s58 offen offset:0 sc1 lds
    s_waitcnt lgkmcnt(6)
    v_mfma_f32_32x32x16_bf16 v[20:35], a[4:7], v[68:71], v[20:35]
    s_waitcnt lgkmcnt(5)
    v_mfma_f32_32x32x16_bf16 v[36:51], a[8:11], v[80:83], v[36:51]
    buffer_load_dwordx4 v2, s[24:27], s58 offen offset:1024 sc1 lds
    s_waitcnt lgkmcnt(4)
    v_mfma_f32_32x32x16_bf16 v[20:35], a[8:11], v[76:79], v[20:35]
    s_waitcnt lgkmcnt(3)
    v_mfma_f32_32x32x16_bf16 v[36:51], a[12:15], v[88:91], v[36:51]
    buffer_load_dwordx4 v2, s[24:27], s58 offen offset:2048 sc1 lds
    s_waitcnt lgkmcnt(2)
    v_mfma_f32_32x32x16_bf16 v[20:35], a[12:15], v[84:87], v[20:35]
    s_waitcnt vmcnt(7)
    s_waitcnt lgkmcnt(0)
    s_barrier
    v_mfma_f32_32x32x16_bf16 v[36:51], a[16:19], v[96:99], v[36:51]
    ds_read_b128 v[72:75], v7 offset:0
    ds_read_b128 v[68:71], v6 offset:0
    buffer_load_dwordx4 v2, s[24:27], s58 offen offset:3072 sc1 lds
    s_add_u32 s58, s58, 8192
    s_add_u32 m0, s55, 16384
    v_mfma_f32_32x32x16_bf16 v[20:35], a[16:19], v[92:95], v[20:35]
    ds_read_b128 v[80:83], v7 offset:2048
    ds_read_b128 v[76:79], v6 offset:2048
    s_waitcnt lgkmcnt(3)
    v_mfma_f32_32x32x16_bf16 v[36:51], a[20:23], v[72:75], v[36:51]
    ds_read_b128 v[88:91], v7 offset:4096
    ds_read_b128 v[84:87], v6 offset:4096
    buffer_load_dwordx4 v2, s[24:27], s58 offen offset:0 sc1 lds
    s_waitcnt lgkmcnt(4)
    v_mfma_f32_32x32x16_bf16 v[20:35], a[20:23], v[68:71], v[20:35]
    ds_read_b128 v[96:99], v7 offset:6144
    ds_read_b128 v[92:95], v6 offset:6144
    s_waitcnt lgkmcnt(5)
    v_mfma_f32_32x32x16_bf16 v[36:51], a[24:27], v[80:83], v[36:51]
    ds_read_b128 v[72:75], v7 offset:24576
    ds_read_b128 v[68:71], v6 offset:24576
    buffer_load_dwordx4 v2, s[24:27], s58 offen offset:1024 sc1 lds
    s_waitcnt lgkmcnt(6)
    v_mfma_f32_32x32x16_bf16 v[20:35], a[24:27], v[76:79], v[20:35]
    s_waitcnt lgkmcnt(5)
    v_mfma_f32_32x32x16_bf16 v[36:51], a[28:31], v[88:91], v[36:51]
    ds_read_b128 v[80:83], v7 offset:26624
    ds_read_b128 v[76:79], v6 offset:26624
    buffer_load_dwordx4 v2, s[24:27], s58 offen offset:2048 sc1 lds
    s_waitcnt lgkmcnt(6)
    v_mfma_f32_32x32x16_bf16 v[20:35], a[28:31], v[84:87], v[20:35]
    s_waitcnt lgkmcnt(5)
    v_mfma_f32_32x32x16_bf16 v[36:51], a[32:35], v[96:99], v[36:51]
    ds_read_b128 v[88:91], v7 offset:28672
    ds_read_b128 v[84:87], v6 offset:28672
    buffer_load_dwordx4 v2, s[24:27], s58 offen offset:3072 sc1 lds
    s_add_u32 s58, s58, 8192
    s_add_u32 m0, s55, 32768
    s_waitcnt lgkmcnt(6)
    v_mfma_f32_32x32x16_bf16 v[20:35], a[32:35], v[92:95], v[20:35]
    s_waitcnt lgkmcnt(5)
    v_mfma_f32_32x32x16_bf16 v[36:51], a[36:39], v[72:75], v[36:51]
    ds_read_b128 v[96:99], v7 offset:30720
    ds_read_b128 v[92:95], v6 offset:30720
    buffer_load_dwordx4 v2, s[24:27], s58 offen offset:0 sc1 lds
    s_waitcnt lgkmcnt(6)
    v_mfma_f32_32x32x16_bf16 v[20:35], a[36:39], v[68:71], v[20:35]
    s_waitcnt lgkmcnt(5)
    v_mfma_f32_32x32x16_bf16 v[36:51], a[40:43], v[80:83], v[36:51]
    buffer_load_dwordx4 v2, s[24:27], s58 offen offset:1024 sc1 lds
    s_waitcnt lgkmcnt(4)
    v_mfma_f32_32x32x16_bf16 v[20:35], a[40:43], v[76:79], v[20:35]
    s_waitcnt lgkmcnt(3)
    v_mfma_f32_32x32x16_bf16 v[36:51], a[44:47], v[88:91], v[36:51]
    buffer_load_dwordx4 v2, s[24:27], s58 offen offset:2048 sc1 lds
    s_waitcnt lgkmcnt(2)
    v_mfma_f32_32x32x16_bf16 v[20:35], a[44:47], v[84:87], v[20:35]
    s_waitcnt vmcnt(7)
    s_waitcnt lgkmcnt(0)
    s_barrier
    v_mfma_f32_32x32x16_bf16 v[36:51], a[48:51], v[96:99], v[36:51]
    ds_read_b128 v[72:75], v7 offset:49152
    ds_read_b128 v[68:71], v6 offset:49152
    buffer_load_dwordx4 v2, s[24:27], s58 offen offset:3072 sc1 lds
    s_add_u32 s58, s58, 8192
    s_add_u32 m0, s55, 49152
    v_mfma_f32_32x32x16_bf16 v[20:35], a[48:51], v[92:95], v[20:35]
    ds_read_b128 v[80:83], v7 offset:51200
    ds_read_b128 v[76:79], v6 offset:51200
    s_waitcnt lgkmcnt(3)
    v_mfma_f32_32x32x16_bf16 v[36:51], a[52:55], v[72:75], v[36:51]
    ds_read_b128 v[88:91], v7 offset:53248
    ds_read_b128 v[84:87], v6 offset:53248
    buffer_load_dwordx4 v2, s[24:27], s58 offen offset:0 sc1 lds
    s_waitcnt lgkmcnt(4)
    v_mfma_f32_32x32x16_bf16 v[20:35], a[52:55], v[68:71], v[20:35]
    ds_read_b128 v[96:99], v7 offset:55296
    ds_read_b128 v[92:95], v6 offset:55296
    s_waitcnt lgkmcnt(5)
    v_mfma_f32_32x32x16_bf16 v[36:51], a[56:59], v[80:83], v[36:51]
    ds_read_b128 v[72:75], v5 offset:0
    ds_read_b128 v[68:71], v4 offset:0
    buffer_load_dwordx4 v2, s[24:27], s58 offen offset:1024 sc1 lds
    s_waitcnt lgkmcnt(6)
    v_mfma_f32_32x32x16_bf16 v[20:35], a[56:59], v[76:79], v[20:35]
    s_waitcnt lgkmcnt(5)
    v_mfma_f32_32x32x16_bf16 v[36:51], a[60:63], v[88:91], v[36:51]
    ds_read_b128 v[80:83], v5 offset:2048
    ds_read_b128 v[76:79], v4 offset:2048
    buffer_load_dwordx4 v2, s[24:27], s58 offen offset:2048 sc1 lds
    s_waitcnt lgkmcnt(6)
    v_mfma_f32_32x32x16_bf16 v[20:35], a[60:63], v[84:87], v[20:35]
    s_waitcnt lgkmcnt(5)
    v_mfma_f32_32x32x16_bf16 v[36:51], v[192:195], v[96:99], v[36:51]
    ds_read_b128 v[88:91], v5 offset:4096
    ds_read_b128 v[84:87], v4 offset:4096
    buffer_load_dwordx4 v2, s[24:27], s58 offen offset:3072 sc1 lds
    s_waitcnt lgkmcnt(6)
    v_mfma_f32_32x32x16_bf16 v[20:35], v[192:195], v[92:95], v[20:35]
    s_waitcnt lgkmcnt(5)
    v_mfma_f32_32x32x16_bf16 v[36:51], v[196:199], v[72:75], v[36:51]
    ds_read_b128 v[96:99], v5 offset:6144
    ds_read_b128 v[92:95], v4 offset:6144
    s_waitcnt lgkmcnt(6)
    v_mfma_f32_32x32x16_bf16 v[20:35], v[196:199], v[68:71], v[20:35]
    s_waitcnt lgkmcnt(5)
    v_mfma_f32_32x32x16_bf16 v[36:51], v[200:203], v[80:83], v[36:51]
    s_waitcnt lgkmcnt(4)
    v_mfma_f32_32x32x16_bf16 v[20:35], v[200:203], v[76:79], v[20:35]
    s_waitcnt lgkmcnt(3)
    v_mfma_f32_32x32x16_bf16 v[36:51], v[204:207], v[88:91], v[36:51]
    s_waitcnt lgkmcnt(2)
    v_mfma_f32_32x32x16_bf16 v[20:35], v[204:207], v[84:87], v[20:35]
    s_waitcnt vmcnt(4)
    s_barrier
    s_waitcnt lgkmcnt(1)
    v_mfma_f32_32x32x16_bf16 v[36:51], v[208:211], v[96:99], v[36:51]
    ds_read_b128 v[72:75], v5 offset:16384
    ds_read_b128 v[68:71], v4 offset:16384
    s_waitcnt lgkmcnt(2)
    v_mfma_f32_32x32x16_bf16 v[20:35], v[208:211], v[92:95], v[20:35]
    ds_read_b128 v[80:83], v5 offset:18432
    ds_read_b128 v[76:79], v4 offset:18432
    s_waitcnt lgkmcnt(3)
    v_mfma_f32_32x32x16_bf16 v[36:51], v[212:215], v[72:75], v[36:51]
    ds_read_b128 v[88:91], v5 offset:20480
    ds_read_b128 v[84:87], v4 offset:20480
    s_waitcnt lgkmcnt(4)
    v_mfma_f32_32x32x16_bf16 v[20:35], v[212:215], v[68:71], v[20:35]
    ds_read_b128 v[96:99], v5 offset:22528
    ds_read_b128 v[92:95], v4 offset:22528
    s_waitcnt lgkmcnt(5)
    v_mfma_f32_32x32x16_bf16 v[36:51], v[216:219], v[80:83], v[36:51]
    ds_read_b128 v[72:75], v5 offset:32768
    ds_read_b128 v[68:71], v4 offset:32768
    s_waitcnt lgkmcnt(6)
    v_mfma_f32_32x32x16_bf16 v[20:35], v[216:219], v[76:79], v[20:35]
    s_waitcnt lgkmcnt(5)
    v_mfma_f32_32x32x16_bf16 v[36:51], v[220:223], v[88:91], v[36:51]
    ds_read_b128 v[80:83], v5 offset:34816
    ds_read_b128 v[76:79], v4 offset:34816
    s_waitcnt lgkmcnt(6)
    v_mfma_f32_32x32x16_bf16 v[20:35], v[220:223], v[84:87], v[20:35]
    s_waitcnt lgkmcnt(5)
    v_mfma_f32_32x32x16_bf16 v[36:51], v[224:227], v[96:99], v[36:51]
    ds_read_b128 v[88:91], v5 offset:36864
    ds_read_b128 v[84:87], v4 offset:36864
    s_waitcnt lgkmcnt(6)
    v_mfma_f32_32x32x16_bf16 v[20:35], v[224:227], v[92:95], v[20:35]
    s_waitcnt lgkmcnt(5)
    v_mfma_f32_32x32x16_bf16 v[36:51], v[228:231], v[72:75], v[36:51]
    ds_read_b128 v[96:99], v5 offset:38912
    ds_read_b128 v[92:95], v4 offset:38912
    s_waitcnt lgkmcnt(6)
    v_mfma_f32_32x32x16_bf16 v[20:35], v[228:231], v[68:71], v[20:35]
    s_waitcnt lgkmcnt(5)
    v_mfma_f32_32x32x16_bf16 v[36:51], v[232:235], v[80:83], v[36:51]
    s_waitcnt lgkmcnt(4)
    v_mfma_f32_32x32x16_bf16 v[20:35], v[232:235], v[76:79], v[20:35]
    s_waitcnt lgkmcnt(3)
    v_mfma_f32_32x32x16_bf16 v[36:51], v[236:239], v[88:91], v[36:51]
    s_waitcnt lgkmcnt(2)
    v_mfma_f32_32x32x16_bf16 v[20:35], v[236:239], v[84:87], v[20:35]
    s_waitcnt vmcnt(0)
    s_barrier
    s_waitcnt lgkmcnt(1)
    v_mfma_f32_32x32x16_bf16 v[36:51], v[240:243], v[96:99], v[36:51]
    ds_read_b128 v[72:75], v5 offset:49152
    ds_read_b128 v[68:71], v4 offset:49152
    s_waitcnt lgkmcnt(2)
    v_mfma_f32_32x32x16_bf16 v[20:35], v[240:243], v[92:95], v[20:35]
    ds_read_b128 v[80:83], v5 offset:51200
    ds_read_b128 v[76:79], v4 offset:51200
    s_waitcnt lgkmcnt(3)
    v_mfma_f32_32x32x16_bf16 v[36:51], v[244:247], v[72:75], v[36:51]
    ds_read_b128 v[88:91], v5 offset:53248
    ds_read_b128 v[84:87], v4 offset:53248
    s_waitcnt lgkmcnt(4)
    v_mfma_f32_32x32x16_bf16 v[20:35], v[244:247], v[68:71], v[20:35]
    s_waitcnt lgkmcnt(3)
    v_mfma_f32_32x32x16_bf16 v[36:51], v[248:251], v[80:83], v[36:51]
    s_waitcnt lgkmcnt(1)
    v_mfma_f32_32x32x16_bf16 v[36:51], v[252:255], v[88:91], v[36:51]
    v_mfma_f32_32x32x16_bf16 v[20:35], v[248:251], v[76:79], v[20:35]
    s_waitcnt lgkmcnt(0)
    v_mfma_f32_32x32x16_bf16 v[20:35], v[252:255], v[84:87], v[20:35]
    s_nop 8
    ds_write_b128 v12, v[36:39] offset:0
    ds_write_b128 v12, v[40:43] offset:1024
    ds_write_b128 v12, v[44:47] offset:2048
    ds_write_b128 v12, v[48:51] offset:3072
    s_waitcnt lgkmcnt(0)
    s_barrier
    ds_read_b128 v[36:39], v13 offset:0
    ds_read_b128 v[40:43], v13 offset:1024
    ds_read_b128 v[44:47], v13 offset:2048
    ds_read_b128 v[48:51], v13 offset:3072
    s_waitcnt lgkmcnt(3)
    v_pk_add_f32 v[20:21], v[20:21], v[36:37]
    v_pk_add_f32 v[22:23], v[22:23], v[38:39]
    s_waitcnt lgkmcnt(2)
    v_pk_add_f32 v[24:25], v[24:25], v[40:41]
    v_pk_add_f32 v[26:27], v[26:27], v[42:43]
    s_waitcnt lgkmcnt(1)
    v_pk_add_f32 v[28:29], v[28:29], v[44:45]
    v_pk_add_f32 v[30:31], v[30:31], v[46:47]
    s_waitcnt lgkmcnt(0)
    s_nop 0
    v_pk_add_f32 v[32:33], v[32:33], v[48:49]
    v_pk_add_f32 v[34:35], v[34:35], v[50:51]
    v_pk_add_f32 v[20:21], v[20:21], v[100:101]
    v_pk_add_f32 v[22:23], v[22:23], v[102:103]
    v_pk_add_f32 v[24:25], v[24:25], v[104:105]
    v_pk_add_f32 v[26:27], v[26:27], v[106:107]
    v_pk_add_f32 v[28:29], v[28:29], v[108:109]
    v_pk_add_f32 v[30:31], v[30:31], v[110:111]
    v_pk_add_f32 v[32:33], v[32:33], v[112:113]
    v_pk_add_f32 v[34:35], v[34:35], v[114:115]
    v_cvt_pk_bf16_f32 v84, v20, v21
    v_cvt_pk_bf16_f32 v85, v22, v23
    v_cvt_pk_bf16_f32 v86, v24, v25
    v_cvt_pk_bf16_f32 v87, v26, v27
    v_cvt_pk_bf16_f32 v88, v28, v29
    v_cvt_pk_bf16_f32 v89, v30, v31
    v_cvt_pk_bf16_f32 v90, v32, v33
    v_cvt_pk_bf16_f32 v91, v34, v35
    buffer_store_dwordx4 v[84:87], v18, s[40:43], 0 offen
    buffer_store_dwordx4 v[88:91], v18, s[40:43], 0 offen offset:16
    s_endpgm
COLD_5:
    s_nop 4
    s_mov_b32 s49, 0
POLL_7:
    buffer_load_dwordx2 v[6:7], v251, s[36:39], s57 offen offset:0 sc1
    s_add_u32 s49, s49, 1
    s_cmp_gt_u32 s49, 0x200000
    s_cbranch_scc1 POLLE_8
    s_waitcnt vmcnt(0)
    v_cmp_ne_u32 vcc, s67, v6
    s_nop 0
    s_cbranch_vccnz POLL_7
POLLE_8:
    s_waitcnt vmcnt(0)
    s_nop 4
    s_branch COLDE_6
ALT_15:
    s_nop 4
    buffer_store_dwordx4 v[20:23], v2, s[20:23], s59 offen sc1
    buffer_store_dwordx4 v[24:27], v2, s[20:23], s59 offen offset:1024 sc1
    buffer_store_dwordx4 v[28:31], v2, s[20:23], s45 offen sc1
    buffer_store_dwordx4 v[136:139], v16, s[36:39], s57 offen sc1
    s_nop 1
    s_branch ALTE_16
ALT_19:
    s_nop 4
    buffer_store_dwordx4 v[84:87], v2, s[24:27], s45 offen sc1
    buffer_store_dwordx4 v[88:91], v2, s[24:27], s45 offen offset:2048 sc1
    s_nop 1
    s_branch ALTE_20
ALT_23:
    s_nop 4
    buffer_store_dwordx4 v[84:87], v2, s[20:23], s45 offen sc1
    buffer_store_dwordx4 v[88:91], v2, s[20:23], s45 offen offset:2048 sc1
    s_nop 1
    s_branch ALTE_24
ALT_25:
    s_nop 4
    buffer_store_dword v36, v14, s[36:39], s57 offen sc1
    s_nop 1
    s_branch ALTE_26
COLD_29:
    s_nop 4
    s_mov_b32 s49, 0
POLL_31:
    buffer_load_dword v14, v3, s[36:39], s66 offen offset:512 sc1
    s_add_u32 s49, s49, 1
    s_cmp_gt_u32 s49, 0x200000
    s_cbranch_scc1 POLLE_32
    s_waitcnt vmcnt(0)
    v_cmp_ne_u32 vcc, s67, v14
    s_nop 0
    s_cbranch_vccnz POLL_31
POLLE_32:
    s_waitcnt vmcnt(0)
    s_nop 4
    s_branch COLDE_30
KS_END:
    s_endpgm
.section .rodata,"a"
.p2align 6
.amdhsa_kernel sequential_preLN__ssm_conv_h3__mixer_s_mlp__prompt_kernel
  .amdhsa_next_free_vgpr 512
  .amdhsa_next_free_sgpr 102
  .amdhsa_accum_offset 256
  .amdhsa_group_segment_fixed_size 0
  .amdhsa_kernarg_size 112
  .amdhsa_user_sgpr_count 2
  .amdhsa_user_sgpr_kernarg_segment_ptr 1
  .amdhsa_system_sgpr_workgroup_id_x 1
  .amdhsa_float_denorm_mode_32 3
.end_amdhsa_kernel
```
